```python
import torch

def _softmax(x, axis=-1):
    return torch.softmax(x, dim=axis)
def _gelu(x):
    return torch.nn.functional.gelu(x, approximate="tanh")
def _silu(x):
    return torch.nn.functional.silu(x)
def _sigmoid(x):
    return torch.sigmoid(x)
def _layernorm(x, axis=-1, eps=1e-5):
    m = x.mean(dim=axis, keepdim=True)
    v = x.var(dim=axis, keepdim=True, unbiased=False)
    return (x - m) / torch.sqrt(v + eps)
def _scatter_add(tgt, idx, src, axis=0):
    return tgt.clone().index_add_(axis, idx, src)
def _segment_sum(src, seg, n):
    out = torch.zeros((n,) + src.shape[1:], dtype=src.dtype)
    return out.index_add_(0, seg, src)
def _pad(x, pw):
    flat = tuple(v for pair in reversed(pw) for v in pair)
    return torch.nn.functional.pad(x, flat)

kernel_name = 'standalone__deep_cross_xdeepfm__recsys'

def setup_inputs():

    _w = (lambda a: (lambda t: t.to(torch.bfloat16) if t.is_floating_point() else t)(torch.as_tensor(a)))
    B, F, D, L = 1024, 26, 32, 3
    V = min(100000, 100000)
    Din = F * D
    return {
        "idx": _w((lambda lo, hi, *s: torch.randint(lo, hi, s))(0, V, B, F).to(torch.int64)),
        "table": _w((lambda *s: torch.randn(*s, dtype=torch.bfloat16) * 1.6)(V, D)),
        "ws_cin": _w((lambda *s: torch.randn(*s, dtype=torch.bfloat16) * 0.1)(L, F, F, F) * (1.0 / F)),
        "w_cin_out": _w((lambda *s: torch.randn(*s, dtype=torch.bfloat16) * 0.1)(L * F) * ((L * F) ** -0.5)),
        "w_dnn1": _w((lambda *s: torch.randn(*s, dtype=torch.bfloat16) * 1.6)(Din, Din) * (Din ** -0.5)),
        "b_dnn1": _w((lambda *s: torch.randn(*s, dtype=torch.bfloat16) * 12.8)(Din) * 0.1),
        "w_dnn2": _w((lambda *s: torch.randn(*s, dtype=torch.bfloat16) * 0.05)(Din) * (Din ** -0.5)),
        "b_out": _w((lambda *s: torch.randn(*s, dtype=torch.bfloat16) * 1.6)(1)),
    }

def reference(idx, table, ws_cin, w_cin_out, w_dnn1, b_dnn1, w_dnn2, b_out):
    x0 = table[idx]
    B = x0.shape[0]
    L = ws_cin.shape[0]
    xk = x0
    pooled = []
    for l in range(L):
        xk = torch.einsum('bid,bjd,hij->bhd', xk, x0, ws_cin[l])
        pooled.append(xk.sum(axis=-1))
    p_plus = torch.stack(pooled, axis=1).reshape(B, -1)
    logit_cin = p_plus @ w_cin_out
    h = x0.reshape(B, -1)
    h = _gelu(h @ w_dnn1 + b_dnn1)
    logit_dnn = h @ w_dnn2
    return logit_cin + logit_dnn + b_out
```

```asm
; @launch grid=(256,1,1) block=(512,1,1) lds=154240
.amdgcn_target "amdgcn-amd-amdhsa--gfx950"
.text
.globl standalone__deep_cross_xdeepfm__recsys_kernel
.p2align 8
.type standalone__deep_cross_xdeepfm__recsys_kernel,@function
standalone__deep_cross_xdeepfm__recsys_kernel:
    s_cmp_ge_u32 s2, 256
    s_cbranch_scc1 L_end
    s_load_dwordx2 s[44:45], s[0:1], 0
    s_load_dwordx2 s[40:41], s[0:1], 80
    s_load_dwordx2 s[32:33], s[0:1], 8
    v_lshrrev_b32 v2, 6, v0
    v_and_b32 v1, 63, v0
    s_and_b32 s8, s2, 7
    v_readfirstlane_b32 s3, v2
    s_lshr_b32 s5, s2, 3
    s_lshr_b32 s9, s2, 6
    s_and_b32 s5, s5, 7
    s_lshr_b32 s6, s8, 2
    s_and_b32 s4, s8, 3
    s_lshl_b32 s4, s4, 2
    s_or_b32 s4, s4, s9
    s_mov_b32 s34, 6400000
    s_mov_b32 s35, 0x20000
    s_mov_b32 s42, 0x200000
    s_mov_b32 s43, 0x20000
    s_mov_b32 s46, 106496
    s_mov_b32 s47, 0x20000
    s_mov_b32 s39, 0x20000
    s_lshl_b32 s11, s4, 7
    s_mul_i32 s7, s6, 6
    s_add_u32 s7, s7, s5
    s_sub_u32 s7, s7, 1
    s_cmp_ge_u32 s3, 4
    s_cbranch_scc1 L_cin
    s_or_b32 s12, s5, s6
    s_cbranch_scc0 L_prod
    s_load_dwordx4 s[16:19], s[0:1], 40
    s_setprio 3
    s_lshl_b32 s12, s4, 2
    s_add_u32 s12, s12, s3
    s_lshl_b32 s12, s12, 4
    s_mul_i32 s13, s12, 104
    s_mul_i32 s15, s3, 1664
    s_add_u32 s15, s15, 147328
    s_mov_b32 m0, s15
    v_lshlrev_b32 v218, 4, v1
    v_mov_b32 v220, 0
    v_lshlrev_b32 v219, 2, v1
    s_lshl_b32 s14, s7, 7
    v_add_u32 v219, s14, v219
    s_waitcnt lgkmcnt(0)
    buffer_load_dwordx4 v218, s[44:47], s13 offen lds
    s_bfm_b64 exec, 40, 0
    buffer_load_dwordx4 v218, s[44:47], s13 offen offset:1024 lds
    s_setprio 0
    s_cmp_le_u32 s5, s6
    s_cbranch_scc1 L_touch
    s_bfm_b64 exec, 32, 0
    s_mov_b32 m0, 153984
    s_nop 0
    global_load_lds_dword v219, s[16:17]
    s_mov_b32 m0, 154112
    s_nop 0
    global_load_lds_dword v219, s[18:19]
    s_mov_b64 exec, -1
    buffer_load_dword v216, v220, s[40:43], s11 offen sc1
    v_bfe_u32 v218, v1, 1, 3
    v_mul_u32_u24 v218, 208, v218
    v_lshrrev_b32 v219, 5, v1
    v_lshl_add_u32 v218, v219, 2, v218
    v_add_u32 v222, s15, v218
    s_lshl_b32 s13, s5, 2
    s_sub_u32 s13, s13, 4
    v_lshrrev_b32 v217, 4, v1
    v_add_u32 v218, s13, v217
    v_min_u32 v218, 25, v218
    v_and_b32 v220, 15, v1
    v_add_u32 v221, s12, v220
    v_mul_u32_u24 v220, 26, v220
    v_add_u32 v220, v220, v218
    v_lshl_add_u32 v184, v220, 2, s15
    v_bfe_u32 v218, v1, 2, 2
    v_lshl_add_u32 v218, v217, 4, v218
    v_lshlrev_b32 v218, 7, v218
    v_and_b32 v219, 3, v1
    v_lshl_add_u32 v218, v219, 3, v218
    v_bfe_u32 v219, v1, 3, 2
    v_xor_b32 v220, 0, v219
    v_lshl_add_u32 v208, v220, 5, v218
    v_add_u32 v212, 0x10000, v208
    v_xor_b32 v220, 1, v219
    v_lshl_add_u32 v209, v220, 5, v218
    v_add_u32 v213, 0x10000, v209
    v_xor_b32 v220, 2, v219
    v_lshl_add_u32 v210, v220, 5, v218
    v_add_u32 v214, 0x10000, v210
    v_xor_b32 v220, 3, v219
    v_lshl_add_u32 v211, v220, 5, v218
    v_add_u32 v215, 0x10000, v211
    v_lshlrev_b32 v218, 3, v217
    v_add_u32 v218, 153984, v218
    v_and_b32 v217, 1, v217
    v_and_b32 v219, 1, v1
    v_lshl_add_u32 v217, v217, 1, v219
    v_lshlrev_b32 v217, 4, v217
    s_add_u32 s14, s7, s12
    s_lshl_b32 s14, s14, 7
    s_add_u32 s14, s14, 0x10000
    v_and_b32 v221, 15, v221
    v_lshlrev_b32 v221, 3, v221
    s_mov_b32 s28, 0x55555555
    s_mov_b32 s29, 0x55555555
    s_waitcnt vmcnt(3)
    ds_read2_b32 v[2:3], v222 offset0:0 offset1:26
    ds_read2_b32 v[4:5], v222 offset0:2 offset1:28
    ds_read2_b32 v[6:7], v222 offset0:4 offset1:30
    ds_read2_b32 v[8:9], v222 offset0:6 offset1:32
    ds_read2_b32 v[10:11], v222 offset0:8 offset1:34
    ds_read2_b32 v[12:13], v222 offset0:10 offset1:36
    ds_read2_b32 v[14:15], v222 offset0:12 offset1:38
    ds_read2_b32 v[16:17], v222 offset0:14 offset1:40
    ds_read2_b32 v[18:19], v222 offset0:16 offset1:42
    ds_read2_b32 v[20:21], v222 offset0:18 offset1:44
    ds_read2_b32 v[22:23], v222 offset0:20 offset1:46
    ds_read2_b32 v[24:25], v222 offset0:22 offset1:48
    ds_read2_b32 v[26:27], v222 offset0:24 offset1:50
    s_waitcnt vmcnt(0)
    ds_read_b64 v[152:153], v218 offset:0
    ds_read_b64 v[154:155], v218 offset:32
    ds_read_b64 v[156:157], v218 offset:64
    ds_read_b64 v[158:159], v218 offset:96
    ds_read_b64 v[160:161], v218 offset:128
    ds_read_b64 v[162:163], v218 offset:160
    ds_read_b64 v[164:165], v218 offset:192
    ds_read_b64 v[166:167], v218 offset:224
    s_waitcnt lgkmcnt(8)
    v_lshl_add_u32 v2, v2, 6, v217
    v_lshl_add_u32 v3, v3, 6, v217
    v_lshl_add_u32 v4, v4, 6, v217
    v_lshl_add_u32 v5, v5, 6, v217
    v_lshl_add_u32 v6, v6, 6, v217
    v_lshl_add_u32 v7, v7, 6, v217
    v_lshl_add_u32 v8, v8, 6, v217
    v_lshl_add_u32 v9, v9, 6, v217
    v_lshl_add_u32 v10, v10, 6, v217
    v_lshl_add_u32 v11, v11, 6, v217
    v_lshl_add_u32 v12, v12, 6, v217
    v_lshl_add_u32 v13, v13, 6, v217
    v_lshl_add_u32 v14, v14, 6, v217
    v_lshl_add_u32 v15, v15, 6, v217
    v_lshl_add_u32 v16, v16, 6, v217
    v_lshl_add_u32 v17, v17, 6, v217
    v_lshl_add_u32 v18, v18, 6, v217
    v_lshl_add_u32 v19, v19, 6, v217
    v_lshl_add_u32 v20, v20, 6, v217
    v_lshl_add_u32 v21, v21, 6, v217
    v_lshl_add_u32 v22, v22, 6, v217
    v_lshl_add_u32 v23, v23, 6, v217
    v_lshl_add_u32 v24, v24, 6, v217
    v_lshl_add_u32 v25, v25, 6, v217
    v_lshl_add_u32 v26, v26, 6, v217
    v_lshl_add_u32 v27, v27, 6, v217
    s_waitcnt lgkmcnt(0)
    v_lshlrev_b32 v136, 16, v152
    v_and_b32 v137, 0xffff0000, v152
    v_lshlrev_b32 v192, 16, v160
    v_and_b32 v193, 0xffff0000, v160
    v_lshlrev_b32 v138, 16, v153
    v_and_b32 v139, 0xffff0000, v153
    v_lshlrev_b32 v194, 16, v161
    v_and_b32 v195, 0xffff0000, v161
    v_lshlrev_b32 v140, 16, v154
    v_and_b32 v141, 0xffff0000, v154
    v_lshlrev_b32 v196, 16, v162
    v_and_b32 v197, 0xffff0000, v162
    v_lshlrev_b32 v142, 16, v155
    v_and_b32 v143, 0xffff0000, v155
    v_lshlrev_b32 v198, 16, v163
    v_and_b32 v199, 0xffff0000, v163
    v_lshlrev_b32 v144, 16, v156
    v_and_b32 v145, 0xffff0000, v156
    v_lshlrev_b32 v200, 16, v164
    v_and_b32 v201, 0xffff0000, v164
    v_lshlrev_b32 v146, 16, v157
    v_and_b32 v147, 0xffff0000, v157
    v_lshlrev_b32 v202, 16, v165
    v_and_b32 v203, 0xffff0000, v165
    v_lshlrev_b32 v148, 16, v158
    v_and_b32 v149, 0xffff0000, v158
    v_lshlrev_b32 v204, 16, v166
    v_and_b32 v205, 0xffff0000, v166
    v_lshlrev_b32 v150, 16, v159
    v_and_b32 v151, 0xffff0000, v159
    v_lshlrev_b32 v206, 16, v167
    v_and_b32 v207, 0xffff0000, v167
    s_barrier
    buffer_load_dwordx4 v[32:35], v2, s[32:35], 0 offen
    buffer_load_dwordx4 v[36:39], v3, s[32:35], 0 offen
    buffer_load_dwordx4 v[40:43], v4, s[32:35], 0 offen
    buffer_load_dwordx4 v[44:47], v5, s[32:35], 0 offen
    buffer_load_dwordx4 v[48:51], v6, s[32:35], 0 offen
    buffer_load_dwordx4 v[52:55], v7, s[32:35], 0 offen
    buffer_load_dwordx4 v[56:59], v8, s[32:35], 0 offen
    buffer_load_dwordx4 v[60:63], v9, s[32:35], 0 offen
    s_barrier
    s_setprio 1
    ds_read_b64_tr_b16 v[152:153], v208 offset:0
    ds_read_b64_tr_b16 v[154:155], v208 offset:512
    ds_read_b64_tr_b16 v[156:157], v209 offset:0
    ds_read_b64_tr_b16 v[158:159], v209 offset:512
    ds_read_b64_tr_b16 v[160:161], v210 offset:0
    ds_read_b64_tr_b16 v[162:163], v210 offset:512
    ds_read_b64_tr_b16 v[164:165], v211 offset:0
    ds_read_b64_tr_b16 v[166:167], v211 offset:512
    ds_read_b64_tr_b16 v[168:169], v208 offset:1024
    ds_read_b64_tr_b16 v[170:171], v208 offset:1536
    ds_read_b64_tr_b16 v[172:173], v209 offset:1024
    ds_read_b64_tr_b16 v[174:175], v209 offset:1536
    buffer_load_dwordx4 v[64:67], v10, s[32:35], 0 offen
    buffer_load_dwordx4 v[68:71], v11, s[32:35], 0 offen
    s_mov_b64 vcc, s[28:29]
    s_waitcnt vmcnt(8)
    v_readfirstlane_b32 s10, v216
    v_cndmask_b32_dpp v184, v36, v32, vcc quad_perm:[1,0,3,2] row_mask:0xf bank_mask:0xf
    v_cndmask_b32_dpp v185, v37, v33, vcc quad_perm:[1,0,3,2] row_mask:0xf bank_mask:0xf
    v_cndmask_b32_dpp v186, v38, v34, vcc quad_perm:[1,0,3,2] row_mask:0xf bank_mask:0xf
    v_cndmask_b32_dpp v187, v39, v35, vcc quad_perm:[1,0,3,2] row_mask:0xf bank_mask:0xf
    s_not_b64 vcc, vcc
    ds_read_b64_tr_b16 v[176:177], v210 offset:1024
    ds_read_b64_tr_b16 v[178:179], v210 offset:1536
    v_cndmask_b32_dpp v36, v32, v36, vcc quad_perm:[1,0,3,2] row_mask:0xf bank_mask:0xf
    s_waitcnt lgkmcnt(10)
    v_mfma_f32_16x16x32_bf16 v[136:139], v[152:155], v[184:187], v[136:139]
    ds_read_b64_tr_b16 v[180:181], v211 offset:1024
    ds_read_b64_tr_b16 v[182:183], v211 offset:1536
    v_cndmask_b32_dpp v37, v33, v37, vcc quad_perm:[1,0,3,2] row_mask:0xf bank_mask:0xf
    v_mfma_f32_16x16x32_bf16 v[140:143], v[156:159], v[184:187], v[140:143]
    ds_read_b64_tr_b16 v[152:153], v208 offset:8192
    ds_read_b64_tr_b16 v[154:155], v208 offset:8704
    v_cndmask_b32_dpp v38, v34, v38, vcc quad_perm:[1,0,3,2] row_mask:0xf bank_mask:0xf
    s_waitcnt lgkmcnt(10)
    v_mfma_f32_16x16x32_bf16 v[144:147], v[160:163], v[184:187], v[144:147]
    ds_read_b64_tr_b16 v[156:157], v209 offset:8192
    ds_read_b64_tr_b16 v[158:159], v209 offset:8704
    v_cndmask_b32_dpp v39, v35, v39, vcc quad_perm:[1,0,3,2] row_mask:0xf bank_mask:0xf
    v_mfma_f32_16x16x32_bf16 v[148:151], v[164:167], v[184:187], v[148:151]
    ds_read_b64_tr_b16 v[160:161], v210 offset:8192
    ds_read_b64_tr_b16 v[162:163], v210 offset:8704
    s_waitcnt lgkmcnt(10)
    v_mfma_f32_16x16x32_bf16 v[136:139], v[168:171], v[36:39], v[136:139]
    ds_read_b64_tr_b16 v[164:165], v211 offset:8192
    ds_read_b64_tr_b16 v[166:167], v211 offset:8704
    v_mfma_f32_16x16x32_bf16 v[140:143], v[172:175], v[36:39], v[140:143]
    ds_read_b64_tr_b16 v[168:169], v208 offset:9216
    ds_read_b64_tr_b16 v[170:171], v208 offset:9728
    s_waitcnt lgkmcnt(10)
    v_mfma_f32_16x16x32_bf16 v[144:147], v[176:179], v[36:39], v[144:147]
    ds_read_b64_tr_b16 v[172:173], v209 offset:9216
    ds_read_b64_tr_b16 v[174:175], v209 offset:9728
    v_mfma_f32_16x16x32_bf16 v[148:151], v[180:183], v[36:39], v[148:151]
    buffer_load_dwordx4 v[72:75], v12, s[32:35], 0 offen
    buffer_load_dwordx4 v[76:79], v13, s[32:35], 0 offen
    s_mov_b64 vcc, s[28:29]
    s_waitcnt vmcnt(8)
    v_cndmask_b32_dpp v188, v44, v40, vcc quad_perm:[1,0,3,2] row_mask:0xf bank_mask:0xf
    v_cndmask_b32_dpp v189, v45, v41, vcc quad_perm:[1,0,3,2] row_mask:0xf bank_mask:0xf
    v_cndmask_b32_dpp v190, v46, v42, vcc quad_perm:[1,0,3,2] row_mask:0xf bank_mask:0xf
    v_cndmask_b32_dpp v191, v47, v43, vcc quad_perm:[1,0,3,2] row_mask:0xf bank_mask:0xf
    s_not_b64 vcc, vcc
    ds_read_b64_tr_b16 v[176:177], v210 offset:9216
    ds_read_b64_tr_b16 v[178:179], v210 offset:9728
    v_cndmask_b32_dpp v44, v40, v44, vcc quad_perm:[1,0,3,2] row_mask:0xf bank_mask:0xf
    s_waitcnt lgkmcnt(10)
    v_mfma_f32_16x16x32_bf16 v[136:139], v[152:155], v[188:191], v[136:139]
    ds_read_b64_tr_b16 v[180:181], v211 offset:9216
    ds_read_b64_tr_b16 v[182:183], v211 offset:9728
    v_cndmask_b32_dpp v45, v41, v45, vcc quad_perm:[1,0,3,2] row_mask:0xf bank_mask:0xf
    v_mfma_f32_16x16x32_bf16 v[140:143], v[156:159], v[188:191], v[140:143]
    ds_read_b64_tr_b16 v[152:153], v208 offset:16384
    ds_read_b64_tr_b16 v[154:155], v208 offset:16896
    v_cndmask_b32_dpp v46, v42, v46, vcc quad_perm:[1,0,3,2] row_mask:0xf bank_mask:0xf
    s_waitcnt lgkmcnt(10)
    v_mfma_f32_16x16x32_bf16 v[144:147], v[160:163], v[188:191], v[144:147]
    ds_read_b64_tr_b16 v[156:157], v209 offset:16384
    ds_read_b64_tr_b16 v[158:159], v209 offset:16896
    v_cndmask_b32_dpp v47, v43, v47, vcc quad_perm:[1,0,3,2] row_mask:0xf bank_mask:0xf
    v_mfma_f32_16x16x32_bf16 v[148:151], v[164:167], v[188:191], v[148:151]
    ds_read_b64_tr_b16 v[160:161], v210 offset:16384
    ds_read_b64_tr_b16 v[162:163], v210 offset:16896
    s_waitcnt lgkmcnt(10)
    v_mfma_f32_16x16x32_bf16 v[136:139], v[168:171], v[44:47], v[136:139]
    ds_read_b64_tr_b16 v[164:165], v211 offset:16384
    ds_read_b64_tr_b16 v[166:167], v211 offset:16896
    v_mfma_f32_16x16x32_bf16 v[140:143], v[172:175], v[44:47], v[140:143]
    ds_read_b64_tr_b16 v[168:169], v208 offset:17408
    ds_read_b64_tr_b16 v[170:171], v208 offset:17920
    s_waitcnt lgkmcnt(10)
    v_mfma_f32_16x16x32_bf16 v[144:147], v[176:179], v[44:47], v[144:147]
    ds_read_b64_tr_b16 v[172:173], v209 offset:17408
    ds_read_b64_tr_b16 v[174:175], v209 offset:17920
    v_mfma_f32_16x16x32_bf16 v[148:151], v[180:183], v[44:47], v[148:151]
    buffer_load_dwordx4 v[80:83], v14, s[32:35], 0 offen
    buffer_load_dwordx4 v[84:87], v15, s[32:35], 0 offen
    s_mov_b64 vcc, s[28:29]
    s_waitcnt vmcnt(8)
    v_cndmask_b32_dpp v184, v52, v48, vcc quad_perm:[1,0,3,2] row_mask:0xf bank_mask:0xf
    v_cndmask_b32_dpp v185, v53, v49, vcc quad_perm:[1,0,3,2] row_mask:0xf bank_mask:0xf
    v_cndmask_b32_dpp v186, v54, v50, vcc quad_perm:[1,0,3,2] row_mask:0xf bank_mask:0xf
    v_cndmask_b32_dpp v187, v55, v51, vcc quad_perm:[1,0,3,2] row_mask:0xf bank_mask:0xf
    s_not_b64 vcc, vcc
    ds_read_b64_tr_b16 v[176:177], v210 offset:17408
    ds_read_b64_tr_b16 v[178:179], v210 offset:17920
    v_cndmask_b32_dpp v52, v48, v52, vcc quad_perm:[1,0,3,2] row_mask:0xf bank_mask:0xf
    s_waitcnt lgkmcnt(10)
    v_mfma_f32_16x16x32_bf16 v[136:139], v[152:155], v[184:187], v[136:139]
    ds_read_b64_tr_b16 v[180:181], v211 offset:17408
    ds_read_b64_tr_b16 v[182:183], v211 offset:17920
    v_cndmask_b32_dpp v53, v49, v53, vcc quad_perm:[1,0,3,2] row_mask:0xf bank_mask:0xf
    v_mfma_f32_16x16x32_bf16 v[140:143], v[156:159], v[184:187], v[140:143]
    ds_read_b64_tr_b16 v[152:153], v208 offset:24576
    ds_read_b64_tr_b16 v[154:155], v208 offset:25088
    v_cndmask_b32_dpp v54, v50, v54, vcc quad_perm:[1,0,3,2] row_mask:0xf bank_mask:0xf
    s_waitcnt lgkmcnt(10)
    v_mfma_f32_16x16x32_bf16 v[144:147], v[160:163], v[184:187], v[144:147]
    ds_read_b64_tr_b16 v[156:157], v209 offset:24576
    ds_read_b64_tr_b16 v[158:159], v209 offset:25088
    v_cndmask_b32_dpp v55, v51, v55, vcc quad_perm:[1,0,3,2] row_mask:0xf bank_mask:0xf
    v_mfma_f32_16x16x32_bf16 v[148:151], v[164:167], v[184:187], v[148:151]
    ds_read_b64_tr_b16 v[160:161], v210 offset:24576
    ds_read_b64_tr_b16 v[162:163], v210 offset:25088
    s_waitcnt lgkmcnt(10)
    v_mfma_f32_16x16x32_bf16 v[136:139], v[168:171], v[52:55], v[136:139]
    ds_read_b64_tr_b16 v[164:165], v211 offset:24576
    ds_read_b64_tr_b16 v[166:167], v211 offset:25088
    v_mfma_f32_16x16x32_bf16 v[140:143], v[172:175], v[52:55], v[140:143]
    ds_read_b64_tr_b16 v[168:169], v208 offset:25600
    ds_read_b64_tr_b16 v[170:171], v208 offset:26112
    s_waitcnt lgkmcnt(10)
    v_mfma_f32_16x16x32_bf16 v[144:147], v[176:179], v[52:55], v[144:147]
    ds_read_b64_tr_b16 v[172:173], v209 offset:25600
    ds_read_b64_tr_b16 v[174:175], v209 offset:26112
    v_mfma_f32_16x16x32_bf16 v[148:151], v[180:183], v[52:55], v[148:151]
    buffer_load_dwordx4 v[88:91], v16, s[32:35], 0 offen
    buffer_load_dwordx4 v[92:95], v17, s[32:35], 0 offen
    s_mov_b64 vcc, s[28:29]
    s_waitcnt vmcnt(8)
    v_cndmask_b32_dpp v188, v60, v56, vcc quad_perm:[1,0,3,2] row_mask:0xf bank_mask:0xf
    v_cndmask_b32_dpp v189, v61, v57, vcc quad_perm:[1,0,3,2] row_mask:0xf bank_mask:0xf
    v_cndmask_b32_dpp v190, v62, v58, vcc quad_perm:[1,0,3,2] row_mask:0xf bank_mask:0xf
    v_cndmask_b32_dpp v191, v63, v59, vcc quad_perm:[1,0,3,2] row_mask:0xf bank_mask:0xf
    s_not_b64 vcc, vcc
    ds_read_b64_tr_b16 v[176:177], v210 offset:25600
    ds_read_b64_tr_b16 v[178:179], v210 offset:26112
    v_cndmask_b32_dpp v60, v56, v60, vcc quad_perm:[1,0,3,2] row_mask:0xf bank_mask:0xf
    s_waitcnt lgkmcnt(10)
    v_mfma_f32_16x16x32_bf16 v[136:139], v[152:155], v[188:191], v[136:139]
    ds_read_b64_tr_b16 v[180:181], v211 offset:25600
    ds_read_b64_tr_b16 v[182:183], v211 offset:26112
    v_cndmask_b32_dpp v61, v57, v61, vcc quad_perm:[1,0,3,2] row_mask:0xf bank_mask:0xf
    v_mfma_f32_16x16x32_bf16 v[140:143], v[156:159], v[188:191], v[140:143]
    ds_read_b64_tr_b16 v[152:153], v208 offset:32768
    ds_read_b64_tr_b16 v[154:155], v208 offset:33280
    v_cndmask_b32_dpp v62, v58, v62, vcc quad_perm:[1,0,3,2] row_mask:0xf bank_mask:0xf
    s_waitcnt lgkmcnt(10)
    v_mfma_f32_16x16x32_bf16 v[144:147], v[160:163], v[188:191], v[144:147]
    ds_read_b64_tr_b16 v[156:157], v209 offset:32768
    ds_read_b64_tr_b16 v[158:159], v209 offset:33280
    v_cndmask_b32_dpp v63, v59, v63, vcc quad_perm:[1,0,3,2] row_mask:0xf bank_mask:0xf
    v_mfma_f32_16x16x32_bf16 v[148:151], v[164:167], v[188:191], v[148:151]
    ds_read_b64_tr_b16 v[160:161], v210 offset:32768
    ds_read_b64_tr_b16 v[162:163], v210 offset:33280
    s_waitcnt lgkmcnt(10)
    v_mfma_f32_16x16x32_bf16 v[136:139], v[168:171], v[60:63], v[136:139]
    ds_read_b64_tr_b16 v[164:165], v211 offset:32768
    ds_read_b64_tr_b16 v[166:167], v211 offset:33280
    v_mfma_f32_16x16x32_bf16 v[140:143], v[172:175], v[60:63], v[140:143]
    ds_read_b64_tr_b16 v[168:169], v208 offset:33792
    ds_read_b64_tr_b16 v[170:171], v208 offset:34304
    s_waitcnt lgkmcnt(10)
    v_mfma_f32_16x16x32_bf16 v[144:147], v[176:179], v[60:63], v[144:147]
    ds_read_b64_tr_b16 v[172:173], v209 offset:33792
    ds_read_b64_tr_b16 v[174:175], v209 offset:34304
    v_mfma_f32_16x16x32_bf16 v[148:151], v[180:183], v[60:63], v[148:151]
    buffer_load_dwordx4 v[96:99], v18, s[32:35], 0 offen
    buffer_load_dwordx4 v[100:103], v19, s[32:35], 0 offen
    s_mov_b64 vcc, s[28:29]
    s_waitcnt vmcnt(8)
    v_cndmask_b32_dpp v184, v68, v64, vcc quad_perm:[1,0,3,2] row_mask:0xf bank_mask:0xf
    v_cndmask_b32_dpp v185, v69, v65, vcc quad_perm:[1,0,3,2] row_mask:0xf bank_mask:0xf
    v_cndmask_b32_dpp v186, v70, v66, vcc quad_perm:[1,0,3,2] row_mask:0xf bank_mask:0xf
    v_cndmask_b32_dpp v187, v71, v67, vcc quad_perm:[1,0,3,2] row_mask:0xf bank_mask:0xf
    s_not_b64 vcc, vcc
    ds_read_b64_tr_b16 v[176:177], v210 offset:33792
    ds_read_b64_tr_b16 v[178:179], v210 offset:34304
    v_cndmask_b32_dpp v68, v64, v68, vcc quad_perm:[1,0,3,2] row_mask:0xf bank_mask:0xf
    s_waitcnt lgkmcnt(10)
    v_mfma_f32_16x16x32_bf16 v[136:139], v[152:155], v[184:187], v[136:139]
    ds_read_b64_tr_b16 v[180:181], v211 offset:33792
    ds_read_b64_tr_b16 v[182:183], v211 offset:34304
    v_cndmask_b32_dpp v69, v65, v69, vcc quad_perm:[1,0,3,2] row_mask:0xf bank_mask:0xf
    v_mfma_f32_16x16x32_bf16 v[140:143], v[156:159], v[184:187], v[140:143]
    ds_read_b64_tr_b16 v[152:153], v208 offset:40960
    ds_read_b64_tr_b16 v[154:155], v208 offset:41472
    v_cndmask_b32_dpp v70, v66, v70, vcc quad_perm:[1,0,3,2] row_mask:0xf bank_mask:0xf
    s_waitcnt lgkmcnt(10)
    v_mfma_f32_16x16x32_bf16 v[144:147], v[160:163], v[184:187], v[144:147]
    ds_read_b64_tr_b16 v[156:157], v209 offset:40960
    ds_read_b64_tr_b16 v[158:159], v209 offset:41472
    v_cndmask_b32_dpp v71, v67, v71, vcc quad_perm:[1,0,3,2] row_mask:0xf bank_mask:0xf
    v_mfma_f32_16x16x32_bf16 v[148:151], v[164:167], v[184:187], v[148:151]
    ds_read_b64_tr_b16 v[160:161], v210 offset:40960
    ds_read_b64_tr_b16 v[162:163], v210 offset:41472
    s_waitcnt lgkmcnt(10)
    v_mfma_f32_16x16x32_bf16 v[136:139], v[168:171], v[68:71], v[136:139]
    ds_read_b64_tr_b16 v[164:165], v211 offset:40960
    ds_read_b64_tr_b16 v[166:167], v211 offset:41472
    v_mfma_f32_16x16x32_bf16 v[140:143], v[172:175], v[68:71], v[140:143]
    ds_read_b64_tr_b16 v[168:169], v208 offset:41984
    ds_read_b64_tr_b16 v[170:171], v208 offset:42496
    s_waitcnt lgkmcnt(10)
    v_mfma_f32_16x16x32_bf16 v[144:147], v[176:179], v[68:71], v[144:147]
    ds_read_b64_tr_b16 v[172:173], v209 offset:41984
    ds_read_b64_tr_b16 v[174:175], v209 offset:42496
    v_mfma_f32_16x16x32_bf16 v[148:151], v[180:183], v[68:71], v[148:151]
    buffer_load_dwordx4 v[104:107], v20, s[32:35], 0 offen
    buffer_load_dwordx4 v[108:111], v21, s[32:35], 0 offen
    s_mov_b64 vcc, s[28:29]
    s_waitcnt vmcnt(8)
    v_cndmask_b32_dpp v188, v76, v72, vcc quad_perm:[1,0,3,2] row_mask:0xf bank_mask:0xf
    v_cndmask_b32_dpp v189, v77, v73, vcc quad_perm:[1,0,3,2] row_mask:0xf bank_mask:0xf
    v_cndmask_b32_dpp v190, v78, v74, vcc quad_perm:[1,0,3,2] row_mask:0xf bank_mask:0xf
    v_cndmask_b32_dpp v191, v79, v75, vcc quad_perm:[1,0,3,2] row_mask:0xf bank_mask:0xf
    s_not_b64 vcc, vcc
    ds_read_b64_tr_b16 v[176:177], v210 offset:41984
    ds_read_b64_tr_b16 v[178:179], v210 offset:42496
    v_cndmask_b32_dpp v76, v72, v76, vcc quad_perm:[1,0,3,2] row_mask:0xf bank_mask:0xf
    s_waitcnt lgkmcnt(10)
    v_mfma_f32_16x16x32_bf16 v[136:139], v[152:155], v[188:191], v[136:139]
    ds_read_b64_tr_b16 v[180:181], v211 offset:41984
    ds_read_b64_tr_b16 v[182:183], v211 offset:42496
    v_cndmask_b32_dpp v77, v73, v77, vcc quad_perm:[1,0,3,2] row_mask:0xf bank_mask:0xf
    v_mfma_f32_16x16x32_bf16 v[140:143], v[156:159], v[188:191], v[140:143]
    ds_read_b64_tr_b16 v[152:153], v208 offset:49152
    ds_read_b64_tr_b16 v[154:155], v208 offset:49664
    v_cndmask_b32_dpp v78, v74, v78, vcc quad_perm:[1,0,3,2] row_mask:0xf bank_mask:0xf
    s_waitcnt lgkmcnt(10)
    v_mfma_f32_16x16x32_bf16 v[144:147], v[160:163], v[188:191], v[144:147]
    ds_read_b64_tr_b16 v[156:157], v209 offset:49152
    ds_read_b64_tr_b16 v[158:159], v209 offset:49664
    v_cndmask_b32_dpp v79, v75, v79, vcc quad_perm:[1,0,3,2] row_mask:0xf bank_mask:0xf
    v_mfma_f32_16x16x32_bf16 v[148:151], v[164:167], v[188:191], v[148:151]
    ds_read_b64_tr_b16 v[160:161], v210 offset:49152
    ds_read_b64_tr_b16 v[162:163], v210 offset:49664
    s_waitcnt lgkmcnt(10)
    v_mfma_f32_16x16x32_bf16 v[136:139], v[168:171], v[76:79], v[136:139]
    ds_read_b64_tr_b16 v[164:165], v211 offset:49152
    ds_read_b64_tr_b16 v[166:167], v211 offset:49664
    v_mfma_f32_16x16x32_bf16 v[140:143], v[172:175], v[76:79], v[140:143]
    ds_read_b64_tr_b16 v[168:169], v208 offset:50176
    ds_read_b64_tr_b16 v[170:171], v208 offset:50688
    s_waitcnt lgkmcnt(10)
    v_mfma_f32_16x16x32_bf16 v[144:147], v[176:179], v[76:79], v[144:147]
    ds_read_b64_tr_b16 v[172:173], v209 offset:50176
    ds_read_b64_tr_b16 v[174:175], v209 offset:50688
    v_mfma_f32_16x16x32_bf16 v[148:151], v[180:183], v[76:79], v[148:151]
    buffer_load_dwordx4 v[112:115], v22, s[32:35], 0 offen
    buffer_load_dwordx4 v[116:119], v23, s[32:35], 0 offen
    s_mov_b64 vcc, s[28:29]
    s_waitcnt vmcnt(8)
    v_cndmask_b32_dpp v184, v84, v80, vcc quad_perm:[1,0,3,2] row_mask:0xf bank_mask:0xf
    v_cndmask_b32_dpp v185, v85, v81, vcc quad_perm:[1,0,3,2] row_mask:0xf bank_mask:0xf
    v_cndmask_b32_dpp v186, v86, v82, vcc quad_perm:[1,0,3,2] row_mask:0xf bank_mask:0xf
    v_cndmask_b32_dpp v187, v87, v83, vcc quad_perm:[1,0,3,2] row_mask:0xf bank_mask:0xf
    s_not_b64 vcc, vcc
    ds_read_b64_tr_b16 v[176:177], v210 offset:50176
    ds_read_b64_tr_b16 v[178:179], v210 offset:50688
    v_cndmask_b32_dpp v84, v80, v84, vcc quad_perm:[1,0,3,2] row_mask:0xf bank_mask:0xf
    s_waitcnt lgkmcnt(10)
    v_mfma_f32_16x16x32_bf16 v[136:139], v[152:155], v[184:187], v[136:139]
    ds_read_b64_tr_b16 v[180:181], v211 offset:50176
    ds_read_b64_tr_b16 v[182:183], v211 offset:50688
    v_cndmask_b32_dpp v85, v81, v85, vcc quad_perm:[1,0,3,2] row_mask:0xf bank_mask:0xf
    v_mfma_f32_16x16x32_bf16 v[140:143], v[156:159], v[184:187], v[140:143]
    ds_read_b64_tr_b16 v[152:153], v208 offset:57344
    ds_read_b64_tr_b16 v[154:155], v208 offset:57856
    v_cndmask_b32_dpp v86, v82, v86, vcc quad_perm:[1,0,3,2] row_mask:0xf bank_mask:0xf
    s_waitcnt lgkmcnt(10)
    v_mfma_f32_16x16x32_bf16 v[144:147], v[160:163], v[184:187], v[144:147]
    ds_read_b64_tr_b16 v[156:157], v209 offset:57344
    ds_read_b64_tr_b16 v[158:159], v209 offset:57856
    v_cndmask_b32_dpp v87, v83, v87, vcc quad_perm:[1,0,3,2] row_mask:0xf bank_mask:0xf
    v_mfma_f32_16x16x32_bf16 v[148:151], v[164:167], v[184:187], v[148:151]
    ds_read_b64_tr_b16 v[160:161], v210 offset:57344
    ds_read_b64_tr_b16 v[162:163], v210 offset:57856
    s_waitcnt lgkmcnt(10)
    v_mfma_f32_16x16x32_bf16 v[136:139], v[168:171], v[84:87], v[136:139]
    ds_read_b64_tr_b16 v[164:165], v211 offset:57344
    ds_read_b64_tr_b16 v[166:167], v211 offset:57856
    v_mfma_f32_16x16x32_bf16 v[140:143], v[172:175], v[84:87], v[140:143]
    ds_read_b64_tr_b16 v[168:169], v208 offset:58368
    ds_read_b64_tr_b16 v[170:171], v208 offset:58880
    s_waitcnt lgkmcnt(10)
    v_mfma_f32_16x16x32_bf16 v[144:147], v[176:179], v[84:87], v[144:147]
    ds_read_b64_tr_b16 v[172:173], v209 offset:58368
    ds_read_b64_tr_b16 v[174:175], v209 offset:58880
    v_mfma_f32_16x16x32_bf16 v[148:151], v[180:183], v[84:87], v[148:151]
    buffer_load_dwordx4 v[120:123], v24, s[32:35], 0 offen
    buffer_load_dwordx4 v[124:127], v25, s[32:35], 0 offen
    s_mov_b64 vcc, s[28:29]
    s_waitcnt vmcnt(8)
    v_cndmask_b32_dpp v188, v92, v88, vcc quad_perm:[1,0,3,2] row_mask:0xf bank_mask:0xf
    v_cndmask_b32_dpp v189, v93, v89, vcc quad_perm:[1,0,3,2] row_mask:0xf bank_mask:0xf
    v_cndmask_b32_dpp v190, v94, v90, vcc quad_perm:[1,0,3,2] row_mask:0xf bank_mask:0xf
    v_cndmask_b32_dpp v191, v95, v91, vcc quad_perm:[1,0,3,2] row_mask:0xf bank_mask:0xf
    s_not_b64 vcc, vcc
    ds_read_b64_tr_b16 v[176:177], v210 offset:58368
    ds_read_b64_tr_b16 v[178:179], v210 offset:58880
    v_cndmask_b32_dpp v92, v88, v92, vcc quad_perm:[1,0,3,2] row_mask:0xf bank_mask:0xf
    s_waitcnt lgkmcnt(10)
    v_mfma_f32_16x16x32_bf16 v[136:139], v[152:155], v[188:191], v[136:139]
    ds_read_b64_tr_b16 v[180:181], v211 offset:58368
    ds_read_b64_tr_b16 v[182:183], v211 offset:58880
    v_cndmask_b32_dpp v93, v89, v93, vcc quad_perm:[1,0,3,2] row_mask:0xf bank_mask:0xf
    v_mfma_f32_16x16x32_bf16 v[140:143], v[156:159], v[188:191], v[140:143]
    ds_read_b64_tr_b16 v[152:153], v212 offset:0
    ds_read_b64_tr_b16 v[154:155], v212 offset:512
    v_cndmask_b32_dpp v94, v90, v94, vcc quad_perm:[1,0,3,2] row_mask:0xf bank_mask:0xf
    s_waitcnt lgkmcnt(10)
    v_mfma_f32_16x16x32_bf16 v[144:147], v[160:163], v[188:191], v[144:147]
    ds_read_b64_tr_b16 v[156:157], v213 offset:0
    ds_read_b64_tr_b16 v[158:159], v213 offset:512
    v_cndmask_b32_dpp v95, v91, v95, vcc quad_perm:[1,0,3,2] row_mask:0xf bank_mask:0xf
    v_mfma_f32_16x16x32_bf16 v[148:151], v[164:167], v[188:191], v[148:151]
    ds_read_b64_tr_b16 v[160:161], v214 offset:0
    ds_read_b64_tr_b16 v[162:163], v214 offset:512
    s_waitcnt lgkmcnt(10)
    v_mfma_f32_16x16x32_bf16 v[136:139], v[168:171], v[92:95], v[136:139]
    ds_read_b64_tr_b16 v[164:165], v215 offset:0
    ds_read_b64_tr_b16 v[166:167], v215 offset:512
    v_mfma_f32_16x16x32_bf16 v[140:143], v[172:175], v[92:95], v[140:143]
    ds_read_b64_tr_b16 v[168:169], v212 offset:1024
    ds_read_b64_tr_b16 v[170:171], v212 offset:1536
    s_waitcnt lgkmcnt(10)
    v_mfma_f32_16x16x32_bf16 v[144:147], v[176:179], v[92:95], v[144:147]
    ds_read_b64_tr_b16 v[172:173], v213 offset:1024
    ds_read_b64_tr_b16 v[174:175], v213 offset:1536
    v_mfma_f32_16x16x32_bf16 v[148:151], v[180:183], v[92:95], v[148:151]
    buffer_load_dwordx4 v[128:131], v26, s[32:35], 0 offen
    buffer_load_dwordx4 v[132:135], v27, s[32:35], 0 offen
    s_mov_b64 vcc, s[28:29]
    s_waitcnt vmcnt(8)
    v_cndmask_b32_dpp v184, v100, v96, vcc quad_perm:[1,0,3,2] row_mask:0xf bank_mask:0xf
    v_cndmask_b32_dpp v185, v101, v97, vcc quad_perm:[1,0,3,2] row_mask:0xf bank_mask:0xf
    v_cndmask_b32_dpp v186, v102, v98, vcc quad_perm:[1,0,3,2] row_mask:0xf bank_mask:0xf
    v_cndmask_b32_dpp v187, v103, v99, vcc quad_perm:[1,0,3,2] row_mask:0xf bank_mask:0xf
    s_not_b64 vcc, vcc
    ds_read_b64_tr_b16 v[176:177], v214 offset:1024
    ds_read_b64_tr_b16 v[178:179], v214 offset:1536
    v_cndmask_b32_dpp v100, v96, v100, vcc quad_perm:[1,0,3,2] row_mask:0xf bank_mask:0xf
    s_waitcnt lgkmcnt(10)
    v_mfma_f32_16x16x32_bf16 v[136:139], v[152:155], v[184:187], v[136:139]
    ds_read_b64_tr_b16 v[180:181], v215 offset:1024
    ds_read_b64_tr_b16 v[182:183], v215 offset:1536
    v_cndmask_b32_dpp v101, v97, v101, vcc quad_perm:[1,0,3,2] row_mask:0xf bank_mask:0xf
    v_mfma_f32_16x16x32_bf16 v[140:143], v[156:159], v[184:187], v[140:143]
    ds_read_b64_tr_b16 v[152:153], v212 offset:8192
    ds_read_b64_tr_b16 v[154:155], v212 offset:8704
    v_cndmask_b32_dpp v102, v98, v102, vcc quad_perm:[1,0,3,2] row_mask:0xf bank_mask:0xf
    s_waitcnt lgkmcnt(10)
    v_mfma_f32_16x16x32_bf16 v[144:147], v[160:163], v[184:187], v[144:147]
    ds_read_b64_tr_b16 v[156:157], v213 offset:8192
    ds_read_b64_tr_b16 v[158:159], v213 offset:8704
    v_cndmask_b32_dpp v103, v99, v103, vcc quad_perm:[1,0,3,2] row_mask:0xf bank_mask:0xf
    v_mfma_f32_16x16x32_bf16 v[148:151], v[164:167], v[184:187], v[148:151]
    ds_read_b64_tr_b16 v[160:161], v214 offset:8192
    ds_read_b64_tr_b16 v[162:163], v214 offset:8704
    s_waitcnt lgkmcnt(10)
    v_mfma_f32_16x16x32_bf16 v[136:139], v[168:171], v[100:103], v[136:139]
    ds_read_b64_tr_b16 v[164:165], v215 offset:8192
    ds_read_b64_tr_b16 v[166:167], v215 offset:8704
    v_mfma_f32_16x16x32_bf16 v[140:143], v[172:175], v[100:103], v[140:143]
    ds_read_b64_tr_b16 v[168:169], v212 offset:9216
    ds_read_b64_tr_b16 v[170:171], v212 offset:9728
    s_waitcnt lgkmcnt(10)
    v_mfma_f32_16x16x32_bf16 v[144:147], v[176:179], v[100:103], v[144:147]
    ds_read_b64_tr_b16 v[172:173], v213 offset:9216
    ds_read_b64_tr_b16 v[174:175], v213 offset:9728
    v_mfma_f32_16x16x32_bf16 v[148:151], v[180:183], v[100:103], v[148:151]
    s_mov_b64 vcc, s[28:29]
    s_waitcnt vmcnt(6)
    v_cndmask_b32_dpp v188, v108, v104, vcc quad_perm:[1,0,3,2] row_mask:0xf bank_mask:0xf
    v_cndmask_b32_dpp v189, v109, v105, vcc quad_perm:[1,0,3,2] row_mask:0xf bank_mask:0xf
    v_cndmask_b32_dpp v190, v110, v106, vcc quad_perm:[1,0,3,2] row_mask:0xf bank_mask:0xf
    v_cndmask_b32_dpp v191, v111, v107, vcc quad_perm:[1,0,3,2] row_mask:0xf bank_mask:0xf
    s_not_b64 vcc, vcc
    ds_read_b64_tr_b16 v[176:177], v214 offset:9216
    ds_read_b64_tr_b16 v[178:179], v214 offset:9728
    v_cndmask_b32_dpp v108, v104, v108, vcc quad_perm:[1,0,3,2] row_mask:0xf bank_mask:0xf
    s_waitcnt lgkmcnt(10)
    v_mfma_f32_16x16x32_bf16 v[136:139], v[152:155], v[188:191], v[136:139]
    ds_read_b64_tr_b16 v[180:181], v215 offset:9216
    ds_read_b64_tr_b16 v[182:183], v215 offset:9728
    v_cndmask_b32_dpp v109, v105, v109, vcc quad_perm:[1,0,3,2] row_mask:0xf bank_mask:0xf
    v_mfma_f32_16x16x32_bf16 v[140:143], v[156:159], v[188:191], v[140:143]
    ds_read_b64_tr_b16 v[152:153], v212 offset:16384
    ds_read_b64_tr_b16 v[154:155], v212 offset:16896
    v_cndmask_b32_dpp v110, v106, v110, vcc quad_perm:[1,0,3,2] row_mask:0xf bank_mask:0xf
    s_waitcnt lgkmcnt(10)
    v_mfma_f32_16x16x32_bf16 v[144:147], v[160:163], v[188:191], v[144:147]
    ds_read_b64_tr_b16 v[156:157], v213 offset:16384
    ds_read_b64_tr_b16 v[158:159], v213 offset:16896
    v_cndmask_b32_dpp v111, v107, v111, vcc quad_perm:[1,0,3,2] row_mask:0xf bank_mask:0xf
    v_mfma_f32_16x16x32_bf16 v[148:151], v[164:167], v[188:191], v[148:151]
    ds_read_b64_tr_b16 v[160:161], v214 offset:16384
    ds_read_b64_tr_b16 v[162:163], v214 offset:16896
    s_waitcnt lgkmcnt(10)
    v_mfma_f32_16x16x32_bf16 v[136:139], v[168:171], v[108:111], v[136:139]
    ds_read_b64_tr_b16 v[164:165], v215 offset:16384
    ds_read_b64_tr_b16 v[166:167], v215 offset:16896
    v_mfma_f32_16x16x32_bf16 v[140:143], v[172:175], v[108:111], v[140:143]
    ds_read_b64_tr_b16 v[168:169], v212 offset:17408
    ds_read_b64_tr_b16 v[170:171], v212 offset:17920
    s_waitcnt lgkmcnt(10)
    v_mfma_f32_16x16x32_bf16 v[144:147], v[176:179], v[108:111], v[144:147]
    ds_read_b64_tr_b16 v[172:173], v213 offset:17408
    ds_read_b64_tr_b16 v[174:175], v213 offset:17920
    v_mfma_f32_16x16x32_bf16 v[148:151], v[180:183], v[108:111], v[148:151]
    s_mov_b64 vcc, s[28:29]
    s_waitcnt vmcnt(4)
    v_cndmask_b32_dpp v184, v116, v112, vcc quad_perm:[1,0,3,2] row_mask:0xf bank_mask:0xf
    v_cndmask_b32_dpp v185, v117, v113, vcc quad_perm:[1,0,3,2] row_mask:0xf bank_mask:0xf
    v_cndmask_b32_dpp v186, v118, v114, vcc quad_perm:[1,0,3,2] row_mask:0xf bank_mask:0xf
    v_cndmask_b32_dpp v187, v119, v115, vcc quad_perm:[1,0,3,2] row_mask:0xf bank_mask:0xf
    s_not_b64 vcc, vcc
    ds_read_b64_tr_b16 v[176:177], v214 offset:17408
    ds_read_b64_tr_b16 v[178:179], v214 offset:17920
    v_cndmask_b32_dpp v116, v112, v116, vcc quad_perm:[1,0,3,2] row_mask:0xf bank_mask:0xf
    s_waitcnt lgkmcnt(10)
    v_mfma_f32_16x16x32_bf16 v[136:139], v[152:155], v[184:187], v[136:139]
    ds_read_b64_tr_b16 v[180:181], v215 offset:17408
    ds_read_b64_tr_b16 v[182:183], v215 offset:17920
    v_cndmask_b32_dpp v117, v113, v117, vcc quad_perm:[1,0,3,2] row_mask:0xf bank_mask:0xf
    v_mfma_f32_16x16x32_bf16 v[140:143], v[156:159], v[184:187], v[140:143]
    ds_read_b64_tr_b16 v[152:153], v212 offset:24576
    ds_read_b64_tr_b16 v[154:155], v212 offset:25088
    v_cndmask_b32_dpp v118, v114, v118, vcc quad_perm:[1,0,3,2] row_mask:0xf bank_mask:0xf
    s_waitcnt lgkmcnt(10)
    v_mfma_f32_16x16x32_bf16 v[144:147], v[160:163], v[184:187], v[144:147]
    ds_read_b64_tr_b16 v[156:157], v213 offset:24576
    ds_read_b64_tr_b16 v[158:159], v213 offset:25088
    v_cndmask_b32_dpp v119, v115, v119, vcc quad_perm:[1,0,3,2] row_mask:0xf bank_mask:0xf
    v_mfma_f32_16x16x32_bf16 v[148:151], v[164:167], v[184:187], v[148:151]
    ds_read_b64_tr_b16 v[160:161], v214 offset:24576
    ds_read_b64_tr_b16 v[162:163], v214 offset:25088
    s_waitcnt lgkmcnt(10)
    v_mfma_f32_16x16x32_bf16 v[136:139], v[168:171], v[116:119], v[136:139]
    ds_read_b64_tr_b16 v[164:165], v215 offset:24576
    ds_read_b64_tr_b16 v[166:167], v215 offset:25088
    v_mfma_f32_16x16x32_bf16 v[140:143], v[172:175], v[116:119], v[140:143]
    ds_read_b64_tr_b16 v[168:169], v212 offset:25600
    ds_read_b64_tr_b16 v[170:171], v212 offset:26112
    s_waitcnt lgkmcnt(10)
    v_mfma_f32_16x16x32_bf16 v[144:147], v[176:179], v[116:119], v[144:147]
    ds_read_b64_tr_b16 v[172:173], v213 offset:25600
    ds_read_b64_tr_b16 v[174:175], v213 offset:26112
    v_mfma_f32_16x16x32_bf16 v[148:151], v[180:183], v[116:119], v[148:151]
    s_mov_b64 vcc, s[28:29]
    s_waitcnt vmcnt(2)
    v_cndmask_b32_dpp v188, v124, v120, vcc quad_perm:[1,0,3,2] row_mask:0xf bank_mask:0xf
    v_cndmask_b32_dpp v189, v125, v121, vcc quad_perm:[1,0,3,2] row_mask:0xf bank_mask:0xf
    v_cndmask_b32_dpp v190, v126, v122, vcc quad_perm:[1,0,3,2] row_mask:0xf bank_mask:0xf
    v_cndmask_b32_dpp v191, v127, v123, vcc quad_perm:[1,0,3,2] row_mask:0xf bank_mask:0xf
    s_not_b64 vcc, vcc
    ds_read_b64_tr_b16 v[176:177], v214 offset:25600
    ds_read_b64_tr_b16 v[178:179], v214 offset:26112
    v_cndmask_b32_dpp v124, v120, v124, vcc quad_perm:[1,0,3,2] row_mask:0xf bank_mask:0xf
    s_waitcnt lgkmcnt(10)
    v_mfma_f32_16x16x32_bf16 v[136:139], v[152:155], v[188:191], v[136:139]
    ds_read_b64_tr_b16 v[180:181], v215 offset:25600
    ds_read_b64_tr_b16 v[182:183], v215 offset:26112
    v_cndmask_b32_dpp v125, v121, v125, vcc quad_perm:[1,0,3,2] row_mask:0xf bank_mask:0xf
    v_mfma_f32_16x16x32_bf16 v[140:143], v[156:159], v[188:191], v[140:143]
    ds_read_b64_tr_b16 v[152:153], v212 offset:32768
    ds_read_b64_tr_b16 v[154:155], v212 offset:33280
    v_cndmask_b32_dpp v126, v122, v126, vcc quad_perm:[1,0,3,2] row_mask:0xf bank_mask:0xf
    s_waitcnt lgkmcnt(10)
    v_mfma_f32_16x16x32_bf16 v[144:147], v[160:163], v[188:191], v[144:147]
    ds_read_b64_tr_b16 v[156:157], v213 offset:32768
    ds_read_b64_tr_b16 v[158:159], v213 offset:33280
    v_cndmask_b32_dpp v127, v123, v127, vcc quad_perm:[1,0,3,2] row_mask:0xf bank_mask:0xf
    v_mfma_f32_16x16x32_bf16 v[148:151], v[164:167], v[188:191], v[148:151]
    ds_read_b64_tr_b16 v[160:161], v214 offset:32768
    ds_read_b64_tr_b16 v[162:163], v214 offset:33280
    s_waitcnt lgkmcnt(10)
    v_mfma_f32_16x16x32_bf16 v[136:139], v[168:171], v[124:127], v[136:139]
    ds_read_b64_tr_b16 v[164:165], v215 offset:32768
    ds_read_b64_tr_b16 v[166:167], v215 offset:33280
    v_mfma_f32_16x16x32_bf16 v[140:143], v[172:175], v[124:127], v[140:143]
    ds_read_b64_tr_b16 v[168:169], v212 offset:33792
    ds_read_b64_tr_b16 v[170:171], v212 offset:34304
    s_waitcnt lgkmcnt(10)
    v_mfma_f32_16x16x32_bf16 v[144:147], v[176:179], v[124:127], v[144:147]
    ds_read_b64_tr_b16 v[172:173], v213 offset:33792
    ds_read_b64_tr_b16 v[174:175], v213 offset:34304
    v_mfma_f32_16x16x32_bf16 v[148:151], v[180:183], v[124:127], v[148:151]
    s_mov_b64 vcc, s[28:29]
    s_waitcnt vmcnt(0)
    v_cndmask_b32_dpp v184, v132, v128, vcc quad_perm:[1,0,3,2] row_mask:0xf bank_mask:0xf
    v_cndmask_b32_dpp v185, v133, v129, vcc quad_perm:[1,0,3,2] row_mask:0xf bank_mask:0xf
    v_cndmask_b32_dpp v186, v134, v130, vcc quad_perm:[1,0,3,2] row_mask:0xf bank_mask:0xf
    v_cndmask_b32_dpp v187, v135, v131, vcc quad_perm:[1,0,3,2] row_mask:0xf bank_mask:0xf
    s_not_b64 vcc, vcc
    ds_read_b64_tr_b16 v[176:177], v214 offset:33792
    ds_read_b64_tr_b16 v[178:179], v214 offset:34304
    v_cndmask_b32_dpp v132, v128, v132, vcc quad_perm:[1,0,3,2] row_mask:0xf bank_mask:0xf
    s_waitcnt lgkmcnt(10)
    v_mfma_f32_16x16x32_bf16 v[136:139], v[152:155], v[184:187], v[136:139]
    ds_read_b64_tr_b16 v[180:181], v215 offset:33792
    ds_read_b64_tr_b16 v[182:183], v215 offset:34304
    v_cndmask_b32_dpp v133, v129, v133, vcc quad_perm:[1,0,3,2] row_mask:0xf bank_mask:0xf
    v_mfma_f32_16x16x32_bf16 v[140:143], v[156:159], v[184:187], v[140:143]
    v_cndmask_b32_dpp v134, v130, v134, vcc quad_perm:[1,0,3,2] row_mask:0xf bank_mask:0xf
    s_waitcnt lgkmcnt(8)
    v_mfma_f32_16x16x32_bf16 v[144:147], v[160:163], v[184:187], v[144:147]
    v_cndmask_b32_dpp v135, v131, v135, vcc quad_perm:[1,0,3,2] row_mask:0xf bank_mask:0xf
    v_mfma_f32_16x16x32_bf16 v[148:151], v[164:167], v[184:187], v[148:151]
    s_waitcnt lgkmcnt(4)
    v_mfma_f32_16x16x32_bf16 v[136:139], v[168:171], v[132:135], v[136:139]
    v_mfma_f32_16x16x32_bf16 v[140:143], v[172:175], v[132:135], v[140:143]
    s_waitcnt lgkmcnt(0)
    v_mfma_f32_16x16x32_bf16 v[144:147], v[176:179], v[132:135], v[144:147]
    v_mfma_f32_16x16x32_bf16 v[148:151], v[180:183], v[132:135], v[148:151]
    s_add_u32 s10, s10, 0x9e3779b9
    s_mov_b32 s11, 0xbdd2d3e8
    v_mov_b32 v218, 0xc0135761
    s_nop 0
    v_mul_f32 v152, v136, v136
    v_mul_f32 v153, v137, v137
    v_mul_f32 v154, v138, v138
    v_mul_f32 v155, v139, v139
    v_mul_f32 v156, v140, v140
    v_mul_f32 v157, v141, v141
    v_mul_f32 v158, v142, v142
    v_mul_f32 v159, v143, v143
    v_mul_f32 v160, v144, v144
    v_mul_f32 v161, v145, v145
    v_mul_f32 v162, v146, v146
    v_mul_f32 v163, v147, v147
    v_mul_f32 v164, v148, v148
    v_mul_f32 v165, v149, v149
    v_mul_f32 v166, v150, v150
    v_mul_f32 v167, v151, v151
    v_fma_f32 v152, v152, s11, v218
    v_fma_f32 v153, v153, s11, v218
    v_fma_f32 v154, v154, s11, v218
    v_fma_f32 v155, v155, s11, v218
    v_fma_f32 v156, v156, s11, v218
    v_fma_f32 v157, v157, s11, v218
    v_fma_f32 v158, v158, s11, v218
    v_fma_f32 v159, v159, s11, v218
    v_fma_f32 v160, v160, s11, v218
    v_fma_f32 v161, v161, s11, v218
    v_fma_f32 v162, v162, s11, v218
    v_fma_f32 v163, v163, s11, v218
    v_fma_f32 v164, v164, s11, v218
    v_fma_f32 v165, v165, s11, v218
    v_fma_f32 v166, v166, s11, v218
    v_fma_f32 v167, v167, s11, v218
    v_mul_f32 v152, v152, v136
    v_mul_f32 v153, v153, v137
    v_mul_f32 v154, v154, v138
    v_mul_f32 v155, v155, v139
    v_mul_f32 v156, v156, v140
    v_mul_f32 v157, v157, v141
    v_mul_f32 v158, v158, v142
    v_mul_f32 v159, v159, v143
    v_mul_f32 v160, v160, v144
    v_mul_f32 v161, v161, v145
    v_mul_f32 v162, v162, v146
    v_mul_f32 v163, v163, v147
    v_mul_f32 v164, v164, v148
    v_mul_f32 v165, v165, v149
    v_mul_f32 v166, v166, v150
    v_mul_f32 v167, v167, v151
    v_exp_f32 v152, v152
    v_mul_f32 v136, v136, v192
    v_exp_f32 v153, v153
    v_mul_f32 v137, v137, v193
    v_exp_f32 v154, v154
    v_mul_f32 v138, v138, v194
    v_exp_f32 v155, v155
    v_mul_f32 v139, v139, v195
    v_exp_f32 v156, v156
    v_mul_f32 v140, v140, v196
    v_exp_f32 v157, v157
    v_mul_f32 v141, v141, v197
    v_exp_f32 v158, v158
    v_mul_f32 v142, v142, v198
    v_exp_f32 v159, v159
    v_mul_f32 v143, v143, v199
    v_exp_f32 v160, v160
    v_mul_f32 v144, v144, v200
    v_exp_f32 v161, v161
    v_mul_f32 v145, v145, v201
    v_exp_f32 v162, v162
    v_mul_f32 v146, v146, v202
    v_exp_f32 v163, v163
    v_mul_f32 v147, v147, v203
    v_exp_f32 v164, v164
    v_mul_f32 v148, v148, v204
    v_exp_f32 v165, v165
    v_mul_f32 v149, v149, v205
    v_exp_f32 v166, v166
    v_mul_f32 v150, v150, v206
    v_exp_f32 v167, v167
    v_mul_f32 v151, v151, v207
    v_add_f32 v152, 1.0, v152
    v_add_f32 v153, 1.0, v153
    v_add_f32 v154, 1.0, v154
    v_add_f32 v155, 1.0, v155
    v_add_f32 v156, 1.0, v156
    v_add_f32 v157, 1.0, v157
    v_add_f32 v158, 1.0, v158
    v_add_f32 v159, 1.0, v159
    v_add_f32 v160, 1.0, v160
    v_add_f32 v161, 1.0, v161
    v_add_f32 v162, 1.0, v162
    v_add_f32 v163, 1.0, v163
    v_add_f32 v164, 1.0, v164
    v_add_f32 v165, 1.0, v165
    v_add_f32 v166, 1.0, v166
    v_add_f32 v167, 1.0, v167
    v_rcp_f32 v152, v152
    v_rcp_f32 v153, v153
    v_rcp_f32 v154, v154
    v_rcp_f32 v155, v155
    v_rcp_f32 v156, v156
    v_rcp_f32 v157, v157
    v_rcp_f32 v158, v158
    v_rcp_f32 v159, v159
    v_rcp_f32 v160, v160
    v_rcp_f32 v161, v161
    v_rcp_f32 v162, v162
    v_rcp_f32 v163, v163
    v_rcp_f32 v164, v164
    v_rcp_f32 v165, v165
    v_rcp_f32 v166, v166
    v_rcp_f32 v167, v167
    v_mul_f32 v218, v136, v152
    v_mul_f32 v219, v137, v153
    v_fmac_f32 v218, v138, v154
    v_fmac_f32 v219, v139, v155
    v_fmac_f32 v218, v140, v156
    v_fmac_f32 v219, v141, v157
    v_fmac_f32 v218, v142, v158
    v_fmac_f32 v219, v143, v159
    v_fmac_f32 v218, v144, v160
    v_fmac_f32 v219, v145, v161
    v_fmac_f32 v218, v146, v162
    v_fmac_f32 v219, v147, v163
    v_fmac_f32 v218, v148, v164
    v_fmac_f32 v219, v149, v165
    v_fmac_f32 v218, v150, v166
    v_fmac_f32 v219, v151, v167
    v_add_f32 v218, v218, v219
    v_mov_b32 v219, v218
    s_nop 1
    v_permlane32_swap_b32 v218, v219
    v_add_f32 v218, v218, v219
    v_mov_b32 v219, v218
    s_nop 1
    v_permlane16_swap_b32 v218, v219
    v_add_f32 v218, v218, v219
    v_mov_b32 v219, s10
    s_mov_b64 exec, 0xffff
    buffer_store_dwordx2 v[218:219], v221, s[40:43], s14 offen sc1
    s_branch L_fin
L_touch:
    s_mov_b64 exec, -1
    s_barrier
    s_lshl_b32 s13, s5, 2
    v_lshrrev_b32 v217, 4, v1
    v_add_u32 v218, s13, v217
    v_and_b32 v220, 15, v1
    v_mul_u32_u24 v220, 104, v220
    v_add_u32 v220, s15, v220
    v_add_u32 v2, 0, v218
    v_min_u32 v2, 25, v2
    v_lshl_add_u32 v2, v2, 2, v220
    v_add_u32 v3, 8, v218
    v_min_u32 v3, 25, v3
    v_lshl_add_u32 v3, v3, 2, v220
    v_add_u32 v4, 16, v218
    v_min_u32 v4, 25, v4
    v_lshl_add_u32 v4, v4, 2, v220
    v_add_u32 v5, 24, v218
    v_min_u32 v5, 25, v5
    v_lshl_add_u32 v5, v5, 2, v220
    s_waitcnt vmcnt(0)
    ds_read_b32 v2, v2
    ds_read_b32 v3, v3
    ds_read_b32 v4, v4
    ds_read_b32 v5, v5
    s_waitcnt lgkmcnt(3)
    v_lshlrev_b32 v2, 6, v2
    buffer_load_dword v10, v2, s[32:35], 0 offen
    s_waitcnt lgkmcnt(2)
    v_lshlrev_b32 v3, 6, v3
    buffer_load_dword v11, v3, s[32:35], 0 offen
    s_waitcnt lgkmcnt(1)
    v_lshlrev_b32 v4, 6, v4
    buffer_load_dword v12, v4, s[32:35], 0 offen
    s_waitcnt lgkmcnt(0)
    v_lshlrev_b32 v5, 6, v5
    buffer_load_dword v13, v5, s[32:35], 0 offen
    s_waitcnt vmcnt(0) lgkmcnt(0)
    s_branch L_fin
L_cin:
    s_load_dwordx2 s[36:37], s[0:1], 32
    s_load_dwordx4 s[20:23], s[0:1], 56
    s_load_dwordx2 s[24:25], s[0:1], 72
    s_setprio 2
    s_lshl_b32 s12, s4, 4
    s_lshl_b32 s13, s6, 3
    s_add_u32 s12, s12, s13
    s_add_u32 s12, s12, s5
    s_lshl_b32 s12, s12, 2
    s_sub_u32 s3, s3, 4
    s_add_u32 s12, s12, s3
    s_mul_i32 s13, s12, 104
    v_mov_b32 v238, 0
    v_mov_b32 v236, 147264
    ds_write_b32 v236, v238
    v_lshrrev_b32 v231, 3, v1
    v_mul_u32_u24 v231, 1664, v231
    v_bfe_u32 v236, v1, 1, 2
    v_bfe_u32 v234, v1, 4, 1
    v_xor_b32 v236, v236, v234
    s_and_b32 s28, s3, 2
    v_xor_b32 v236, s28, v236
    v_lshl_add_u32 v231, v236, 5, v231
    v_and_b32 v236, 1, v1
    v_lshl_add_u32 v231, v236, 4, v231
    s_mov_b32 s38, 1384448
    s_lshl_b32 s19, s3, 10
    s_mul_i32 s17, s19, 13
    s_lshl_b32 s28, s7, 7
    s_add_u32 s17, s17, s28
    s_add_u32 s18, s17, 1384448
    s_mul_i32 s28, s9, 13
    s_add_u32 s28, s28, 1
    s_lshr_b32 s28, s28, 1
    s_lshl_b32 s28, s28, 12
    s_add_u32 m0, s28, s19
    s_mul_i32 s16, s28, 13
    s_add_u32 s16, s16, s17
    s_waitcnt lgkmcnt(0)
    s_buffer_load_dwordx16 s[48:63], s[44:47], s13
    s_buffer_load_dwordx8 s[64:71], s[44:47], s13 offset:64
    s_buffer_load_dwordx2 s[72:73], s[44:47], s13 offset:96
    s_cmp_le_u32 s5, s6
    s_cbranch_scc1 L_cin_a
    buffer_load_dwordx4 v231, s[36:39], s16 offen lds
    s_add_u32 s16, s16, 53248
    s_add_u32 m0, m0, 4096
    s_cmp_eq_u32 s16, s18
    s_cselect_b32 s16, s17, s16
    s_cselect_b32 m0, s19, m0
    s_nop 0
    buffer_load_dwordx4 v231, s[36:39], s16 offen lds
    s_add_u32 s16, s16, 53248
    s_add_u32 m0, m0, 4096
    s_cmp_eq_u32 s16, s18
    s_cselect_b32 s16, s17, s16
    s_cselect_b32 m0, s19, m0
    s_nop 0
    buffer_load_dwordx4 v231, s[36:39], s16 offen lds
    s_add_u32 s16, s16, 53248
    s_add_u32 m0, m0, 4096
    s_cmp_eq_u32 s16, s18
    s_cselect_b32 s16, s17, s16
    s_cselect_b32 m0, s19, m0
    s_nop 0
    buffer_load_dwordx4 v231, s[36:39], s16 offen lds
    s_add_u32 s16, s16, 53248
    s_add_u32 m0, m0, 4096
    s_cmp_eq_u32 s16, s18
    s_cselect_b32 s16, s17, s16
    s_cselect_b32 m0, s19, m0
    s_nop 0
    buffer_load_dwordx4 v231, s[36:39], s16 offen lds
    s_add_u32 s16, s16, 53248
    s_add_u32 m0, m0, 4096
    s_cmp_eq_u32 s16, s18
    s_cselect_b32 s16, s17, s16
    s_cselect_b32 m0, s19, m0
    s_nop 0
    buffer_load_dwordx4 v231, s[36:39], s16 offen lds
    s_add_u32 s16, s16, 53248
    s_add_u32 m0, m0, 4096
    s_cmp_eq_u32 s16, s18
    s_cselect_b32 s16, s17, s16
    s_cselect_b32 m0, s19, m0
    s_nop 0
    buffer_load_dwordx4 v231, s[36:39], s16 offen lds
    s_branch L_cin_b
L_cin_a:
    s_barrier
L_cin_b:
    v_mov_b32 v32, 0
    v_mov_b32 v33, 0
    v_mov_b32 v34, 0
    v_mov_b32 v35, 0
    v_mov_b32 v36, 0
    v_mov_b32 v37, 0
    v_mov_b32 v38, 0
    v_mov_b32 v39, 0
    v_mov_b32 v40, 0
    v_mov_b32 v41, 0
    v_mov_b32 v42, 0
    v_mov_b32 v43, 0
    v_mov_b32 v44, 0
    v_mov_b32 v45, 0
    v_mov_b32 v46, 0
    v_mov_b32 v47, 0
    v_mov_b32 v48, 0
    v_mov_b32 v49, 0
    v_mov_b32 v50, 0
    v_mov_b32 v51, 0
    v_mov_b32 v52, 0
    v_mov_b32 v53, 0
    v_mov_b32 v54, 0
    v_mov_b32 v55, 0
    v_mov_b32 v56, 0
    v_mov_b32 v57, 0
    v_lshrrev_b32 v239, 5, v1
    v_and_b32 v236, 31, v1
    v_min_u32 v234, 25, v236
    v_mul_u32_u24 v234, 784, v234
    v_lshl_add_u32 v234, v239, 4, v234
    v_add_u32 v234, 0x1a000, v234
    v_lshlrev_b32 v236, 1, v236
    v_lshlrev_b32 v230, 6, v239
    v_sub_u32 v229, 64, v230
    s_and_b32 s14, s12, 0xfff0
    s_lshl_b32 s14, s14, 4
    s_and_b32 s30, s12, 15
    s_add_u32 s14, s14, s30
    s_lshl_b32 s14, s14, 3
    s_add_u32 s14, s14, 0x10000
    v_lshlrev_b32 v235, 7, v1
    buffer_load_dword v232, v238, s[40:43], s11 offen sc1
    global_load_ushort v233, v238, s[20:21]
    s_waitcnt lgkmcnt(0)
    v_mad_u32_u24 v2, v230, s49, v236
    v_mad_u32_u24 v2, v229, s48, v2
    buffer_load_short_d16_hi v32, v2, s[32:35], 0 offen
    v_mad_u32_u24 v3, v230, s50, v236
    v_mad_u32_u24 v3, v229, s49, v3
    buffer_load_short_d16_hi v33, v3, s[32:35], 0 offen
    v_mad_u32_u24 v4, v230, s51, v236
    v_mad_u32_u24 v4, v229, s50, v4
    buffer_load_short_d16_hi v34, v4, s[32:35], 0 offen
    v_mad_u32_u24 v5, v230, s52, v236
    v_mad_u32_u24 v5, v229, s51, v5
    buffer_load_short_d16_hi v35, v5, s[32:35], 0 offen
    v_mad_u32_u24 v6, v230, s53, v236
    v_mad_u32_u24 v6, v229, s52, v6
    buffer_load_short_d16_hi v36, v6, s[32:35], 0 offen
    v_mad_u32_u24 v7, v230, s54, v236
    v_mad_u32_u24 v7, v229, s53, v7
    buffer_load_short_d16_hi v37, v7, s[32:35], 0 offen
    v_mad_u32_u24 v8, v230, s55, v236
    v_mad_u32_u24 v8, v229, s54, v8
    buffer_load_short_d16_hi v38, v8, s[32:35], 0 offen
    v_mad_u32_u24 v9, v230, s56, v236
    v_mad_u32_u24 v9, v229, s55, v9
    buffer_load_short_d16_hi v39, v9, s[32:35], 0 offen
    v_mad_u32_u24 v10, v230, s57, v236
    v_mad_u32_u24 v10, v229, s56, v10
    buffer_load_short_d16_hi v40, v10, s[32:35], 0 offen
    v_mad_u32_u24 v11, v230, s58, v236
    v_mad_u32_u24 v11, v229, s57, v11
    buffer_load_short_d16_hi v41, v11, s[32:35], 0 offen
    v_mad_u32_u24 v12, v230, s59, v236
    v_mad_u32_u24 v12, v229, s58, v12
    buffer_load_short_d16_hi v42, v12, s[32:35], 0 offen
    v_mad_u32_u24 v13, v230, s60, v236
    v_mad_u32_u24 v13, v229, s59, v13
    buffer_load_short_d16_hi v43, v13, s[32:35], 0 offen
    v_mad_u32_u24 v14, v230, s61, v236
    v_mad_u32_u24 v14, v229, s60, v14
    buffer_load_short_d16_hi v44, v14, s[32:35], 0 offen
    v_mad_u32_u24 v15, v230, s62, v236
    v_mad_u32_u24 v15, v229, s61, v15
    buffer_load_short_d16_hi v45, v15, s[32:35], 0 offen
    v_mad_u32_u24 v16, v230, s63, v236
    v_mad_u32_u24 v16, v229, s62, v16
    buffer_load_short_d16_hi v46, v16, s[32:35], 0 offen
    v_mad_u32_u24 v17, v230, s64, v236
    v_mad_u32_u24 v17, v229, s63, v17
    buffer_load_short_d16_hi v47, v17, s[32:35], 0 offen
    v_mad_u32_u24 v18, v230, s65, v236
    v_mad_u32_u24 v18, v229, s64, v18
    buffer_load_short_d16_hi v48, v18, s[32:35], 0 offen
    v_mad_u32_u24 v19, v230, s66, v236
    v_mad_u32_u24 v19, v229, s65, v19
    buffer_load_short_d16_hi v49, v19, s[32:35], 0 offen
    v_mad_u32_u24 v20, v230, s67, v236
    v_mad_u32_u24 v20, v229, s66, v20
    buffer_load_short_d16_hi v50, v20, s[32:35], 0 offen
    v_mad_u32_u24 v21, v230, s68, v236
    v_mad_u32_u24 v21, v229, s67, v21
    buffer_load_short_d16_hi v51, v21, s[32:35], 0 offen
    v_mad_u32_u24 v22, v230, s69, v236
    v_mad_u32_u24 v22, v229, s68, v22
    buffer_load_short_d16_hi v52, v22, s[32:35], 0 offen
    v_mad_u32_u24 v23, v230, s70, v236
    v_mad_u32_u24 v23, v229, s69, v23
    buffer_load_short_d16_hi v53, v23, s[32:35], 0 offen
    v_mad_u32_u24 v24, v230, s71, v236
    v_mad_u32_u24 v24, v229, s70, v24
    buffer_load_short_d16_hi v54, v24, s[32:35], 0 offen
    v_mad_u32_u24 v25, v230, s72, v236
    v_mad_u32_u24 v25, v229, s71, v25
    buffer_load_short_d16_hi v55, v25, s[32:35], 0 offen
    v_mad_u32_u24 v26, v230, s73, v236
    v_mad_u32_u24 v26, v229, s72, v26
    buffer_load_short_d16_hi v56, v26, s[32:35], 0 offen
    v_mad_u32_u24 v27, v230, s48, v236
    v_mad_u32_u24 v27, v229, s73, v27
    buffer_load_short_d16_hi v57, v27, s[32:35], 0 offen
    v_lshlrev_b32 v237, 2, v1
    s_cmp_le_u32 s5, s6
    s_cbranch_scc0 L_cin_d
    s_cmp_eq_u32 s6, 0
    s_cbranch_scc0 L_cin_e
    s_barrier
L_cin_e:
    s_waitcnt vmcnt(0)
    s_branch L_cin_f
L_cin_d:
    s_add_u32 s16, s16, 53248
    s_add_u32 m0, m0, 4096
    s_cmp_eq_u32 s16, s18
    s_cselect_b32 s16, s17, s16
    s_cselect_b32 m0, s19, m0
    s_nop 0
    buffer_load_dwordx4 v231, s[36:39], s16 offen lds
    s_add_u32 s16, s16, 53248
    s_add_u32 m0, m0, 4096
    s_cmp_eq_u32 s16, s18
    s_cselect_b32 s16, s17, s16
    s_cselect_b32 m0, s19, m0
    s_nop 0
    buffer_load_dwordx4 v231, s[36:39], s16 offen lds
    s_add_u32 s16, s16, 53248
    s_add_u32 m0, m0, 4096
    s_cmp_eq_u32 s16, s18
    s_cselect_b32 s16, s17, s16
    s_cselect_b32 m0, s19, m0
    s_nop 0
    buffer_load_dwordx4 v231, s[36:39], s16 offen lds
    s_add_u32 s16, s16, 53248
    s_add_u32 m0, m0, 4096
    s_cmp_eq_u32 s16, s18
    s_cselect_b32 s16, s17, s16
    s_cselect_b32 m0, s19, m0
    s_nop 0
    buffer_load_dwordx4 v231, s[36:39], s16 offen lds
    s_add_u32 s16, s16, 53248
    s_add_u32 m0, m0, 4096
    s_cmp_eq_u32 s16, s18
    s_cselect_b32 s16, s17, s16
    s_cselect_b32 m0, s19, m0
    s_nop 0
    buffer_load_dwordx4 v231, s[36:39], s16 offen lds
    s_add_u32 s16, s16, 53248
    s_add_u32 m0, m0, 4096
    s_cmp_eq_u32 s16, s18
    s_cselect_b32 s16, s17, s16
    s_cselect_b32 m0, s19, m0
    s_nop 0
    buffer_load_dwordx4 v231, s[36:39], s16 offen lds
    s_add_u32 s16, s16, 53248
    s_add_u32 m0, m0, 4096
    s_cmp_eq_u32 s16, s18
    s_cselect_b32 s16, s17, s16
    s_cselect_b32 m0, s19, m0
    s_nop 0
    buffer_load_dwordx4 v231, s[36:39], s16 offen lds
    s_add_u32 s16, s16, 53248
    s_add_u32 m0, m0, 4096
    s_cmp_eq_u32 s16, s18
    s_cselect_b32 s16, s17, s16
    s_cselect_b32 m0, s19, m0
    s_nop 0
    buffer_load_dwordx4 v231, s[36:39], s16 offen lds
    s_add_u32 s16, s16, 53248
    s_add_u32 m0, m0, 4096
    s_cmp_eq_u32 s16, s18
    s_cselect_b32 s16, s17, s16
    s_cselect_b32 m0, s19, m0
    s_nop 0
    buffer_load_dwordx4 v231, s[36:39], s16 offen lds
    s_add_u32 s16, s16, 53248
    s_add_u32 m0, m0, 4096
    s_cmp_eq_u32 s16, s18
    s_cselect_b32 s16, s17, s16
    s_cselect_b32 m0, s19, m0
    s_nop 0
    buffer_load_dwordx4 v231, s[36:39], s16 offen lds
    s_add_u32 s16, s16, 53248
    s_add_u32 m0, m0, 4096
    s_cmp_eq_u32 s16, s18
    s_cselect_b32 s16, s17, s16
    s_cselect_b32 m0, s19, m0
    s_nop 0
    buffer_load_dwordx4 v231, s[36:39], s16 offen lds
    s_add_u32 s16, s16, 53248
    s_add_u32 m0, m0, 4096
    s_cmp_eq_u32 s16, s18
    s_cselect_b32 s16, s17, s16
    s_cselect_b32 m0, s19, m0
    s_nop 0
    buffer_load_dwordx4 v231, s[36:39], s16 offen lds
    s_add_u32 s16, s16, 53248
    s_add_u32 m0, m0, 4096
    s_cmp_eq_u32 s16, s18
    s_cselect_b32 s16, s17, s16
    s_cselect_b32 m0, s19, m0
    s_nop 0
    buffer_load_dwordx4 v231, s[36:39], s16 offen lds
    s_add_u32 s16, s16, 53248
    s_add_u32 m0, m0, 4096
    s_cmp_eq_u32 s16, s18
    s_cselect_b32 s16, s17, s16
    s_cselect_b32 m0, s19, m0
    s_nop 0
    buffer_load_dwordx4 v231, s[36:39], s16 offen lds
    s_add_u32 s16, s16, 53248
    s_add_u32 m0, m0, 4096
    s_cmp_eq_u32 s16, s18
    s_cselect_b32 s16, s17, s16
    s_cselect_b32 m0, s19, m0
    s_nop 0
    buffer_load_dwordx4 v231, s[36:39], s16 offen lds
    s_add_u32 s16, s16, 53248
    s_add_u32 m0, m0, 4096
    s_cmp_eq_u32 s16, s18
    s_cselect_b32 s16, s17, s16
    s_cselect_b32 m0, s19, m0
    s_nop 0
    buffer_load_dwordx4 v231, s[36:39], s16 offen lds
    s_add_u32 s16, s16, 53248
    s_add_u32 m0, m0, 4096
    s_cmp_eq_u32 s16, s18
    s_cselect_b32 s16, s17, s16
    s_cselect_b32 m0, s19, m0
    s_nop 0
    buffer_load_dwordx4 v231, s[36:39], s16 offen lds
    s_add_u32 s16, s16, 53248
    s_add_u32 m0, m0, 4096
    s_cmp_eq_u32 s16, s18
    s_cselect_b32 s16, s17, s16
    s_cselect_b32 m0, s19, m0
    s_nop 0
    buffer_load_dwordx4 v231, s[36:39], s16 offen lds
    s_add_u32 s16, s16, 53248
    s_add_u32 m0, m0, 4096
    s_cmp_eq_u32 s16, s18
    s_cselect_b32 s16, s17, s16
    s_cselect_b32 m0, s19, m0
    s_nop 0
    buffer_load_dwordx4 v231, s[36:39], s16 offen lds
    s_barrier
    s_waitcnt vmcnt(19)
L_cin_f:
    s_setprio 0
    v_readfirstlane_b32 s10, v232
    v_pk_mul_f32 v[192:193], v[32:33], v[32:33] op_sel_hi:[0,1]
    v_pk_mul_f32 v[194:195], v[32:33], v[34:35] op_sel_hi:[0,1]
    v_pk_mul_f32 v[196:197], v[32:33], v[36:37] op_sel_hi:[0,1]
    v_cvt_pk_bf16_f32 v64, v192, v193
    v_pk_mul_f32 v[198:199], v[32:33], v[38:39] op_sel_hi:[0,1]
    v_cvt_pk_bf16_f32 v65, v194, v195
    v_pk_mul_f32 v[200:201], v[32:33], v[40:41] op_sel_hi:[0,1]
    v_cvt_pk_bf16_f32 v66, v196, v197
    v_pk_mul_f32 v[202:203], v[32:33], v[42:43] op_sel_hi:[0,1]
    v_cvt_pk_bf16_f32 v67, v198, v199
    v_pk_mul_f32 v[204:205], v[32:33], v[44:45] op_sel_hi:[0,1]
    v_cvt_pk_bf16_f32 v68, v200, v201
    v_pk_mul_f32 v[206:207], v[34:35], v[34:35] op_sel_hi:[0,1]
    v_cvt_pk_bf16_f32 v69, v202, v203
    v_pk_mul_f32 v[192:193], v[34:35], v[36:37] op_sel_hi:[0,1]
    v_cvt_pk_bf16_f32 v70, v204, v205
    v_pk_mul_f32 v[194:195], v[34:35], v[38:39] op_sel_hi:[0,1]
    v_cvt_pk_bf16_f32 v71, v206, v207
    v_pk_mul_f32 v[196:197], v[34:35], v[40:41] op_sel_hi:[0,1]
    v_cvt_pk_bf16_f32 v72, v192, v193
    v_pk_mul_f32 v[198:199], v[34:35], v[42:43] op_sel_hi:[0,1]
    v_cvt_pk_bf16_f32 v73, v194, v195
    v_pk_mul_f32 v[200:201], v[34:35], v[44:45] op_sel_hi:[0,1]
    v_cvt_pk_bf16_f32 v74, v196, v197
    v_pk_mul_f32 v[202:203], v[34:35], v[46:47] op_sel_hi:[0,1]
    v_cvt_pk_bf16_f32 v75, v198, v199
    v_pk_mul_f32 v[204:205], v[36:37], v[36:37] op_sel_hi:[0,1]
    v_cvt_pk_bf16_f32 v76, v200, v201
    v_pk_mul_f32 v[206:207], v[36:37], v[38:39] op_sel_hi:[0,1]
    v_cvt_pk_bf16_f32 v77, v202, v203
    v_pk_mul_f32 v[192:193], v[36:37], v[40:41] op_sel_hi:[0,1]
    v_cvt_pk_bf16_f32 v78, v204, v205
    v_pk_mul_f32 v[194:195], v[36:37], v[42:43] op_sel_hi:[0,1]
    v_cvt_pk_bf16_f32 v79, v206, v207
    v_pk_mul_f32 v[196:197], v[36:37], v[44:45] op_sel_hi:[0,1]
    v_cvt_pk_bf16_f32 v80, v192, v193
    v_pk_mul_f32 v[198:199], v[36:37], v[46:47] op_sel_hi:[0,1]
    v_cvt_pk_bf16_f32 v81, v194, v195
    v_pk_mul_f32 v[200:201], v[36:37], v[48:49] op_sel_hi:[0,1]
    v_cvt_pk_bf16_f32 v82, v196, v197
    v_pk_mul_f32 v[202:203], v[38:39], v[38:39] op_sel_hi:[0,1]
    v_cvt_pk_bf16_f32 v83, v198, v199
    v_pk_mul_f32 v[204:205], v[38:39], v[40:41] op_sel_hi:[0,1]
    v_cvt_pk_bf16_f32 v84, v200, v201
    v_pk_mul_f32 v[206:207], v[38:39], v[42:43] op_sel_hi:[0,1]
    v_cvt_pk_bf16_f32 v85, v202, v203
    v_pk_mul_f32 v[192:193], v[38:39], v[44:45] op_sel_hi:[0,1]
    v_cvt_pk_bf16_f32 v86, v204, v205
    v_pk_mul_f32 v[194:195], v[38:39], v[46:47] op_sel_hi:[0,1]
    v_cvt_pk_bf16_f32 v87, v206, v207
    v_pk_mul_f32 v[196:197], v[38:39], v[48:49] op_sel_hi:[0,1]
    v_cvt_pk_bf16_f32 v88, v192, v193
    v_pk_mul_f32 v[198:199], v[38:39], v[50:51] op_sel_hi:[0,1]
    v_cvt_pk_bf16_f32 v89, v194, v195
    v_pk_mul_f32 v[200:201], v[40:41], v[40:41] op_sel_hi:[0,1]
    v_cvt_pk_bf16_f32 v90, v196, v197
    v_pk_mul_f32 v[202:203], v[40:41], v[42:43] op_sel_hi:[0,1]
    v_cvt_pk_bf16_f32 v91, v198, v199
    v_pk_mul_f32 v[204:205], v[40:41], v[44:45] op_sel_hi:[0,1]
    v_cvt_pk_bf16_f32 v92, v200, v201
    v_pk_mul_f32 v[206:207], v[40:41], v[46:47] op_sel_hi:[0,1]
    v_cvt_pk_bf16_f32 v93, v202, v203
    v_pk_mul_f32 v[192:193], v[40:41], v[48:49] op_sel_hi:[0,1]
    v_cvt_pk_bf16_f32 v94, v204, v205
    v_pk_mul_f32 v[194:195], v[40:41], v[50:51] op_sel_hi:[0,1]
    v_cvt_pk_bf16_f32 v95, v206, v207
    v_pk_mul_f32 v[196:197], v[40:41], v[52:53] op_sel_hi:[0,1]
    v_cvt_pk_bf16_f32 v96, v192, v193
    v_pk_mul_f32 v[198:199], v[42:43], v[42:43] op_sel_hi:[0,1]
    v_cvt_pk_bf16_f32 v97, v194, v195
    v_pk_mul_f32 v[200:201], v[42:43], v[44:45] op_sel_hi:[0,1]
    v_cvt_pk_bf16_f32 v98, v196, v197
    v_pk_mul_f32 v[202:203], v[42:43], v[46:47] op_sel_hi:[0,1]
    v_cvt_pk_bf16_f32 v99, v198, v199
    v_pk_mul_f32 v[204:205], v[42:43], v[48:49] op_sel_hi:[0,1]
    v_cvt_pk_bf16_f32 v100, v200, v201
    v_pk_mul_f32 v[206:207], v[42:43], v[50:51] op_sel_hi:[0,1]
    v_cvt_pk_bf16_f32 v101, v202, v203
    v_pk_mul_f32 v[192:193], v[42:43], v[52:53] op_sel_hi:[0,1]
    v_cvt_pk_bf16_f32 v102, v204, v205
    v_pk_mul_f32 v[194:195], v[42:43], v[54:55] op_sel_hi:[0,1]
    v_cvt_pk_bf16_f32 v103, v206, v207
    v_pk_mul_f32 v[196:197], v[44:45], v[44:45] op_sel_hi:[0,1]
    v_cvt_pk_bf16_f32 v104, v192, v193
    v_pk_mul_f32 v[198:199], v[44:45], v[46:47] op_sel_hi:[0,1]
    v_cvt_pk_bf16_f32 v105, v194, v195
    v_pk_mul_f32 v[200:201], v[44:45], v[48:49] op_sel_hi:[0,1]
    v_cvt_pk_bf16_f32 v106, v196, v197
    v_pk_mul_f32 v[202:203], v[44:45], v[50:51] op_sel_hi:[0,1]
    v_cvt_pk_bf16_f32 v107, v198, v199
    v_pk_mul_f32 v[204:205], v[44:45], v[52:53] op_sel_hi:[0,1]
    v_cvt_pk_bf16_f32 v108, v200, v201
    v_pk_mul_f32 v[206:207], v[44:45], v[54:55] op_sel_hi:[0,1]
    v_cvt_pk_bf16_f32 v109, v202, v203
    v_pk_mul_f32 v[192:193], v[44:45], v[56:57] op_sel_hi:[0,1]
    v_cvt_pk_bf16_f32 v110, v204, v205
    v_pk_mul_f32 v[194:195], v[46:47], v[46:47] op_sel_hi:[0,1]
    v_cvt_pk_bf16_f32 v111, v206, v207
    v_pk_mul_f32 v[196:197], v[46:47], v[48:49] op_sel_hi:[0,1]
    v_cvt_pk_bf16_f32 v112, v192, v193
    v_pk_mul_f32 v[198:199], v[46:47], v[50:51] op_sel_hi:[0,1]
    v_cvt_pk_bf16_f32 v113, v194, v195
    v_pk_mul_f32 v[200:201], v[46:47], v[52:53] op_sel_hi:[0,1]
    v_cvt_pk_bf16_f32 v114, v196, v197
    v_pk_mul_f32 v[202:203], v[46:47], v[54:55] op_sel_hi:[0,1]
    v_cvt_pk_bf16_f32 v115, v198, v199
    v_pk_mul_f32 v[204:205], v[46:47], v[56:57] op_sel_hi:[0,1]
    v_cvt_pk_bf16_f32 v116, v200, v201
    v_mul_f32 v206, v46, v32
    v_cvt_pk_bf16_f32 v117, v202, v203
    v_pk_mul_f32 v[192:193], v[48:49], v[48:49] op_sel_hi:[0,1]
    v_cvt_pk_bf16_f32 v118, v204, v205
    v_pk_mul_f32 v[194:195], v[48:49], v[50:51] op_sel_hi:[0,1]
    v_cvt_pk_bf16_f32 v119, v206, v46
    v_pk_mul_f32 v[196:197], v[48:49], v[52:53] op_sel_hi:[0,1]
    v_cvt_pk_bf16_f32 v120, v192, v193
    v_pk_mul_f32 v[198:199], v[48:49], v[54:55] op_sel_hi:[0,1]
    v_cvt_pk_bf16_f32 v121, v194, v195
    v_pk_mul_f32 v[200:201], v[48:49], v[56:57] op_sel_hi:[0,1]
    v_cvt_pk_bf16_f32 v122, v196, v197
    v_pk_mul_f32 v[202:203], v[48:49], v[32:33] op_sel_hi:[0,1]
    v_cvt_pk_bf16_f32 v123, v198, v199
    v_mul_f32 v204, v48, v34
    v_cvt_pk_bf16_f32 v124, v200, v201
    v_pk_mul_f32 v[206:207], v[50:51], v[50:51] op_sel_hi:[0,1]
    v_cvt_pk_bf16_f32 v125, v202, v203
    v_pk_mul_f32 v[192:193], v[50:51], v[52:53] op_sel_hi:[0,1]
    v_cvt_pk_bf16_f32 v126, v204, v48
    v_pk_mul_f32 v[194:195], v[50:51], v[54:55] op_sel_hi:[0,1]
    v_cvt_pk_bf16_f32 v127, v206, v207
    v_pk_mul_f32 v[196:197], v[50:51], v[56:57] op_sel_hi:[0,1]
    v_cvt_pk_bf16_f32 v128, v192, v193
    v_pk_mul_f32 v[198:199], v[50:51], v[32:33] op_sel_hi:[0,1]
    v_cvt_pk_bf16_f32 v129, v194, v195
    v_pk_mul_f32 v[200:201], v[50:51], v[34:35] op_sel_hi:[0,1]
    v_cvt_pk_bf16_f32 v130, v196, v197
    v_mul_f32 v202, v50, v36
    v_cvt_pk_bf16_f32 v131, v198, v199
    v_pk_mul_f32 v[204:205], v[52:53], v[52:53] op_sel_hi:[0,1]
    v_cvt_pk_bf16_f32 v132, v200, v201
    v_pk_mul_f32 v[206:207], v[52:53], v[54:55] op_sel_hi:[0,1]
    v_cvt_pk_bf16_f32 v133, v202, v50
    v_pk_mul_f32 v[192:193], v[52:53], v[56:57] op_sel_hi:[0,1]
    v_cvt_pk_bf16_f32 v134, v204, v205
    v_pk_mul_f32 v[194:195], v[52:53], v[32:33] op_sel_hi:[0,1]
    v_cvt_pk_bf16_f32 v135, v206, v207
    v_pk_mul_f32 v[196:197], v[52:53], v[34:35] op_sel_hi:[0,1]
    v_cvt_pk_bf16_f32 v136, v192, v193
    v_pk_mul_f32 v[198:199], v[52:53], v[36:37] op_sel_hi:[0,1]
    v_cvt_pk_bf16_f32 v137, v194, v195
    v_mul_f32 v200, v52, v38
    v_cvt_pk_bf16_f32 v138, v196, v197
    v_pk_mul_f32 v[202:203], v[54:55], v[54:55] op_sel_hi:[0,1]
    v_cvt_pk_bf16_f32 v139, v198, v199
    v_pk_mul_f32 v[204:205], v[54:55], v[56:57] op_sel_hi:[0,1]
    v_cvt_pk_bf16_f32 v140, v200, v52
    v_pk_mul_f32 v[206:207], v[54:55], v[32:33] op_sel_hi:[0,1]
    v_cvt_pk_bf16_f32 v141, v202, v203
    v_pk_mul_f32 v[192:193], v[54:55], v[34:35] op_sel_hi:[0,1]
    v_cvt_pk_bf16_f32 v142, v204, v205
    v_pk_mul_f32 v[194:195], v[54:55], v[36:37] op_sel_hi:[0,1]
    v_cvt_pk_bf16_f32 v143, v206, v207
    v_pk_mul_f32 v[196:197], v[54:55], v[38:39] op_sel_hi:[0,1]
    v_cvt_pk_bf16_f32 v144, v192, v193
    v_mul_f32 v198, v54, v40
    v_cvt_pk_bf16_f32 v145, v194, v195
    v_pk_mul_f32 v[200:201], v[56:57], v[56:57] op_sel_hi:[0,1]
    v_cvt_pk_bf16_f32 v146, v196, v197
    v_pk_mul_f32 v[202:203], v[56:57], v[32:33] op_sel_hi:[0,1]
    v_cvt_pk_bf16_f32 v147, v198, v54
    v_pk_mul_f32 v[204:205], v[56:57], v[34:35] op_sel_hi:[0,1]
    v_cvt_pk_bf16_f32 v148, v200, v201
    v_pk_mul_f32 v[206:207], v[56:57], v[36:37] op_sel_hi:[0,1]
    v_cvt_pk_bf16_f32 v149, v202, v203
    v_pk_mul_f32 v[192:193], v[56:57], v[38:39] op_sel_hi:[0,1]
    v_cvt_pk_bf16_f32 v150, v204, v205
    v_pk_mul_f32 v[194:195], v[56:57], v[40:41] op_sel_hi:[0,1]
    v_cvt_pk_bf16_f32 v151, v206, v207
    v_mul_f32 v196, v56, v42
    v_cvt_pk_bf16_f32 v152, v192, v193
    v_cvt_pk_bf16_f32 v153, v194, v195
    v_cvt_pk_bf16_f32 v154, v196, v56
    v_cvt_pk_bf16_f32 v155, v32, v34
    v_cvt_pk_bf16_f32 v156, v36, v38
    v_cvt_pk_bf16_f32 v157, v40, v42
    v_cvt_pk_bf16_f32 v158, v44, 1.0
    v_mov_b32 v159, 0
    s_add_u32 s10, s10, 0x9e3779b9
    s_cmp_le_u32 s5, s6
    s_cbranch_scc1 L_cin_g
    s_waitcnt vmcnt(0)
    s_barrier
L_cin_g:
    s_mov_b32 s15, 200000
    v_mov_b32 v236, 147264
    s_cmp_eq_u32 s3, 0
    s_cbranch_scc0 L_nopoll
    s_bfm_b64 exec, 13, 0
    s_lshl_b32 s13, s4, 8
    s_add_u32 s13, s13, 0x8000
L_pollS:
    buffer_load_dword v238, v237, s[40:43], s13 offen sc1
    s_sub_u32 s15, s15, 1
    s_cbranch_scc1 L_pollS_done
    s_waitcnt vmcnt(0)
    v_cmp_ne_u32 vcc, s10, v238
    s_nop 0
    s_cbranch_vccnz L_pollS
L_pollS_done:
    s_bfm_b64 exec, 48, 0
    v_lshlrev_b32 v237, 4, v1
    s_mov_b32 s13, 0x40000
    s_mov_b32 m0, 0x1a000
    s_nop 0
    buffer_load_dwordx4 v237, s[40:43], s13 offen offset:0 lds
    s_add_u32 m0, m0, 16
    s_nop 0
    buffer_load_dwordx4 v237, s[40:43], s13 offen offset:768 lds
    s_add_u32 m0, m0, 16
    s_nop 0
    buffer_load_dwordx4 v237, s[40:43], s13 offen offset:1536 lds
    s_add_u32 m0, m0, 16
    s_nop 0
    buffer_load_dwordx4 v237, s[40:43], s13 offen offset:2304 lds
    s_add_u32 m0, m0, 16
    s_nop 0
    buffer_load_dwordx4 v237, s[40:43], s13 offen offset:3072 lds
    s_add_u32 m0, m0, 3856
    s_add_u32 s13, s13, 3840
    buffer_load_dwordx4 v237, s[40:43], s13 offen offset:0 lds
    s_add_u32 m0, m0, 16
    s_nop 0
    buffer_load_dwordx4 v237, s[40:43], s13 offen offset:768 lds
    s_add_u32 m0, m0, 16
    s_nop 0
    buffer_load_dwordx4 v237, s[40:43], s13 offen offset:1536 lds
    s_add_u32 m0, m0, 16
    s_nop 0
    buffer_load_dwordx4 v237, s[40:43], s13 offen offset:2304 lds
    s_add_u32 m0, m0, 16
    s_nop 0
    buffer_load_dwordx4 v237, s[40:43], s13 offen offset:3072 lds
    s_add_u32 m0, m0, 3856
    s_add_u32 s13, s13, 3840
    buffer_load_dwordx4 v237, s[40:43], s13 offen offset:0 lds
    s_add_u32 m0, m0, 16
    s_nop 0
    buffer_load_dwordx4 v237, s[40:43], s13 offen offset:768 lds
    s_add_u32 m0, m0, 16
    s_nop 0
    buffer_load_dwordx4 v237, s[40:43], s13 offen offset:1536 lds
    s_add_u32 m0, m0, 16
    s_nop 0
    buffer_load_dwordx4 v237, s[40:43], s13 offen offset:2304 lds
    s_add_u32 m0, m0, 16
    s_nop 0
    buffer_load_dwordx4 v237, s[40:43], s13 offen offset:3072 lds
    s_add_u32 m0, m0, 3856
    s_add_u32 s13, s13, 3840
    buffer_load_dwordx4 v237, s[40:43], s13 offen offset:0 lds
    s_add_u32 m0, m0, 16
    s_nop 0
    buffer_load_dwordx4 v237, s[40:43], s13 offen offset:768 lds
    s_add_u32 m0, m0, 16
    s_nop 0
    buffer_load_dwordx4 v237, s[40:43], s13 offen offset:1536 lds
    s_add_u32 m0, m0, 16
    s_nop 0
    buffer_load_dwordx4 v237, s[40:43], s13 offen offset:2304 lds
    s_add_u32 m0, m0, 16
    s_nop 0
    buffer_load_dwordx4 v237, s[40:43], s13 offen offset:3072 lds
    s_add_u32 m0, m0, 3856
    s_add_u32 s13, s13, 3840
    buffer_load_dwordx4 v237, s[40:43], s13 offen offset:0 lds
    s_add_u32 m0, m0, 16
    s_nop 0
    buffer_load_dwordx4 v237, s[40:43], s13 offen offset:768 lds
    s_add_u32 m0, m0, 16
    s_nop 0
    buffer_load_dwordx4 v237, s[40:43], s13 offen offset:1536 lds
    s_add_u32 m0, m0, 16
    s_nop 0
    buffer_load_dwordx4 v237, s[40:43], s13 offen offset:2304 lds
    s_add_u32 m0, m0, 16
    s_nop 0
    buffer_load_dwordx4 v237, s[40:43], s13 offen offset:3072 lds
    s_add_u32 m0, m0, 3856
    s_add_u32 s13, s13, 3840
    buffer_load_dwordx4 v237, s[40:43], s13 offen offset:0 lds
    s_add_u32 m0, m0, 16
    s_nop 0
    buffer_load_dwordx4 v237, s[40:43], s13 offen offset:768 lds
    s_add_u32 m0, m0, 16
    s_nop 0
    buffer_load_dwordx4 v237, s[40:43], s13 offen offset:1536 lds
    s_add_u32 m0, m0, 16
    s_nop 0
    buffer_load_dwordx4 v237, s[40:43], s13 offen offset:2304 lds
    s_add_u32 m0, m0, 16
    s_nop 0
    buffer_load_dwordx4 v237, s[40:43], s13 offen offset:3072 lds
    s_add_u32 m0, m0, 3856
    s_add_u32 s13, s13, 3840
    buffer_load_dwordx4 v237, s[40:43], s13 offen offset:0 lds
    s_add_u32 m0, m0, 16
    s_nop 0
    buffer_load_dwordx4 v237, s[40:43], s13 offen offset:768 lds
    s_add_u32 m0, m0, 16
    s_nop 0
    buffer_load_dwordx4 v237, s[40:43], s13 offen offset:1536 lds
    s_add_u32 m0, m0, 16
    s_nop 0
    buffer_load_dwordx4 v237, s[40:43], s13 offen offset:2304 lds
    s_add_u32 m0, m0, 16
    s_nop 0
    buffer_load_dwordx4 v237, s[40:43], s13 offen offset:3072 lds
    s_add_u32 m0, m0, 3856
    s_add_u32 s13, s13, 3840
    buffer_load_dwordx4 v237, s[40:43], s13 offen offset:0 lds
    s_add_u32 m0, m0, 16
    s_nop 0
    buffer_load_dwordx4 v237, s[40:43], s13 offen offset:768 lds
    s_add_u32 m0, m0, 16
    s_nop 0
    buffer_load_dwordx4 v237, s[40:43], s13 offen offset:1536 lds
    s_add_u32 m0, m0, 16
    s_nop 0
    buffer_load_dwordx4 v237, s[40:43], s13 offen offset:2304 lds
    s_add_u32 m0, m0, 16
    s_nop 0
    buffer_load_dwordx4 v237, s[40:43], s13 offen offset:3072 lds
    s_add_u32 m0, m0, 3856
    s_add_u32 s13, s13, 3840
    buffer_load_dwordx4 v237, s[40:43], s13 offen offset:0 lds
    s_add_u32 m0, m0, 16
    s_nop 0
    buffer_load_dwordx4 v237, s[40:43], s13 offen offset:768 lds
    s_add_u32 m0, m0, 16
    s_nop 0
    buffer_load_dwordx4 v237, s[40:43], s13 offen offset:1536 lds
    s_add_u32 m0, m0, 16
    s_nop 0
    buffer_load_dwordx4 v237, s[40:43], s13 offen offset:2304 lds
    s_add_u32 m0, m0, 16
    s_nop 0
    buffer_load_dwordx4 v237, s[40:43], s13 offen offset:3072 lds
    s_add_u32 m0, m0, 3856
    s_add_u32 s13, s13, 3840
    buffer_load_dwordx4 v237, s[40:43], s13 offen offset:0 lds
    s_add_u32 m0, m0, 16
    s_nop 0
    buffer_load_dwordx4 v237, s[40:43], s13 offen offset:768 lds
    s_add_u32 m0, m0, 16
    s_nop 0
    buffer_load_dwordx4 v237, s[40:43], s13 offen offset:1536 lds
    s_add_u32 m0, m0, 16
    s_nop 0
    buffer_load_dwordx4 v237, s[40:43], s13 offen offset:2304 lds
    s_add_u32 m0, m0, 16
    s_nop 0
    buffer_load_dwordx4 v237, s[40:43], s13 offen offset:3072 lds
    s_add_u32 m0, m0, 3856
    s_add_u32 s13, s13, 3840
    buffer_load_dwordx4 v237, s[40:43], s13 offen offset:0 lds
    s_add_u32 m0, m0, 16
    s_nop 0
    buffer_load_dwordx4 v237, s[40:43], s13 offen offset:768 lds
    s_mov_b64 exec, 1
    v_mov_b32 v237, 4
    s_mov_b32 s15, 200000
    s_waitcnt vmcnt(0)
    ds_write_b32 v236, v237
    s_branch L_pollL_done
L_nopoll:
    s_mov_b64 exec, 1
    s_mov_b32 s15, 3200000
L_pollL:
    ds_read_b32 v238, v236
    s_sub_u32 s15, s15, 1
    s_cbranch_scc1 L_pollL_done
    s_waitcnt lgkmcnt(0)
    v_cmp_gt_u32 vcc, 4, v238
    s_nop 0
    s_cbranch_vccnz L_pollL
L_pollL_done:
    s_mov_b64 exec, -1
    s_cmp_le_u32 s5, s6
    s_cbranch_scc0 L_nodummy
    s_cmp_eq_u32 s3, 0
    s_cbranch_scc0 L_nodummy
    s_add_u32 s13, s6, s5
    s_lshl_b32 s13, s13, 7
    s_lshl_b32 s15, s4, 13
    s_add_u32 s13, s13, s15
    s_add_u32 s13, s13, 0x10680
    v_lshrrev_b32 v237, 4, v1
    v_and_b32 v224, 15, v1
    v_lshlrev_b32 v224, 3, v224
    v_lshl_add_u32 v237, v237, 11, v224
    v_mov_b32 v224, 0
    v_mov_b32 v225, s10
    buffer_store_dwordx2 v[224:225], v237, s[40:43], s13 offen sc1
L_nodummy:
    ds_read_b128 v[192:195], v234 offset:0
    ds_read_b128 v[196:199], v234 offset:20384
    ds_read_b128 v[200:203], v234 offset:32
    ds_read_b128 v[204:207], v234 offset:20416
    ds_read_b128 v[208:211], v234 offset:64
    ds_read_b128 v[212:215], v234 offset:20448
    ds_read_b128 v[216:219], v234 offset:96
    s_waitcnt lgkmcnt(6)
    v_mfma_f32_32x32x16_bf16 v[160:175], v[192:195], v[64:67], 0
    ds_read_b128 v[220:223], v234 offset:20480
    s_waitcnt lgkmcnt(6)
    v_mfma_f32_32x32x16_bf16 v[176:191], v[196:199], v[64:67], 0
    ds_read_b128 v[192:195], v234 offset:128
    s_waitcnt lgkmcnt(6)
    v_mfma_f32_32x32x16_bf16 v[160:175], v[200:203], v[68:71], v[160:175]
    ds_read_b128 v[196:199], v234 offset:20512
    s_waitcnt lgkmcnt(6)
    v_mfma_f32_32x32x16_bf16 v[176:191], v[204:207], v[68:71], v[176:191]
    ds_read_b128 v[200:203], v234 offset:160
    s_waitcnt lgkmcnt(6)
    v_mfma_f32_32x32x16_bf16 v[160:175], v[208:211], v[72:75], v[160:175]
    ds_read_b128 v[204:207], v234 offset:20544
    s_waitcnt lgkmcnt(6)
    v_mfma_f32_32x32x16_bf16 v[176:191], v[212:215], v[72:75], v[176:191]
    ds_read_b128 v[208:211], v234 offset:192
    s_waitcnt lgkmcnt(6)
    v_mfma_f32_32x32x16_bf16 v[160:175], v[216:219], v[76:79], v[160:175]
    ds_read_b128 v[212:215], v234 offset:20576
    s_waitcnt lgkmcnt(6)
    v_mfma_f32_32x32x16_bf16 v[176:191], v[220:223], v[76:79], v[176:191]
    ds_read_b128 v[216:219], v234 offset:224
    s_waitcnt lgkmcnt(6)
    v_mfma_f32_32x32x16_bf16 v[160:175], v[192:195], v[80:83], v[160:175]
    ds_read_b128 v[220:223], v234 offset:20608
    s_waitcnt lgkmcnt(6)
    v_mfma_f32_32x32x16_bf16 v[176:191], v[196:199], v[80:83], v[176:191]
    ds_read_b128 v[192:195], v234 offset:256
    s_waitcnt lgkmcnt(6)
    v_mfma_f32_32x32x16_bf16 v[160:175], v[200:203], v[84:87], v[160:175]
    ds_read_b128 v[196:199], v234 offset:20640
    s_waitcnt lgkmcnt(6)
    v_mfma_f32_32x32x16_bf16 v[176:191], v[204:207], v[84:87], v[176:191]
    ds_read_b128 v[200:203], v234 offset:288
    s_waitcnt lgkmcnt(6)
    v_mfma_f32_32x32x16_bf16 v[160:175], v[208:211], v[88:91], v[160:175]
    ds_read_b128 v[204:207], v234 offset:20672
    s_waitcnt lgkmcnt(6)
    v_mfma_f32_32x32x16_bf16 v[176:191], v[212:215], v[88:91], v[176:191]
    ds_read_b128 v[208:211], v234 offset:320
    s_waitcnt lgkmcnt(6)
    v_mfma_f32_32x32x16_bf16 v[160:175], v[216:219], v[92:95], v[160:175]
    ds_read_b128 v[212:215], v234 offset:20704
    s_waitcnt lgkmcnt(6)
    v_mfma_f32_32x32x16_bf16 v[176:191], v[220:223], v[92:95], v[176:191]
    ds_read_b128 v[216:219], v234 offset:352
    s_waitcnt lgkmcnt(6)
    v_mfma_f32_32x32x16_bf16 v[160:175], v[192:195], v[96:99], v[160:175]
    ds_read_b128 v[220:223], v234 offset:20736
    s_waitcnt lgkmcnt(6)
    v_mfma_f32_32x32x16_bf16 v[176:191], v[196:199], v[96:99], v[176:191]
    ds_read_b128 v[192:195], v234 offset:384
    s_waitcnt lgkmcnt(6)
    v_mfma_f32_32x32x16_bf16 v[160:175], v[200:203], v[100:103], v[160:175]
    ds_read_b128 v[196:199], v234 offset:20768
    s_waitcnt lgkmcnt(6)
    v_mfma_f32_32x32x16_bf16 v[176:191], v[204:207], v[100:103], v[176:191]
    ds_read_b128 v[200:203], v234 offset:416
    s_waitcnt lgkmcnt(6)
    v_mfma_f32_32x32x16_bf16 v[160:175], v[208:211], v[104:107], v[160:175]
    ds_read_b128 v[204:207], v234 offset:20800
    s_waitcnt lgkmcnt(6)
    v_mfma_f32_32x32x16_bf16 v[176:191], v[212:215], v[104:107], v[176:191]
    ds_read_b128 v[208:211], v234 offset:448
    s_waitcnt lgkmcnt(6)
    v_mfma_f32_32x32x16_bf16 v[160:175], v[216:219], v[108:111], v[160:175]
    ds_read_b128 v[212:215], v234 offset:20832
    s_waitcnt lgkmcnt(6)
    v_mfma_f32_32x32x16_bf16 v[176:191], v[220:223], v[108:111], v[176:191]
    ds_read_b128 v[216:219], v234 offset:480
    s_waitcnt lgkmcnt(6)
    v_mfma_f32_32x32x16_bf16 v[160:175], v[192:195], v[112:115], v[160:175]
    ds_read_b128 v[220:223], v234 offset:20864
    s_waitcnt lgkmcnt(6)
    v_mfma_f32_32x32x16_bf16 v[176:191], v[196:199], v[112:115], v[176:191]
    ds_read_b128 v[192:195], v234 offset:512
    s_waitcnt lgkmcnt(6)
    v_mfma_f32_32x32x16_bf16 v[160:175], v[200:203], v[116:119], v[160:175]
    ds_read_b128 v[196:199], v234 offset:20896
    s_waitcnt lgkmcnt(6)
    v_mfma_f32_32x32x16_bf16 v[176:191], v[204:207], v[116:119], v[176:191]
    ds_read_b128 v[200:203], v234 offset:544
    s_waitcnt lgkmcnt(6)
    v_mfma_f32_32x32x16_bf16 v[160:175], v[208:211], v[120:123], v[160:175]
    ds_read_b128 v[204:207], v234 offset:20928
    s_waitcnt lgkmcnt(6)
    v_mfma_f32_32x32x16_bf16 v[176:191], v[212:215], v[120:123], v[176:191]
    ds_read_b128 v[208:211], v234 offset:576
    s_waitcnt lgkmcnt(6)
    v_mfma_f32_32x32x16_bf16 v[160:175], v[216:219], v[124:127], v[160:175]
    ds_read_b128 v[212:215], v234 offset:20960
    s_waitcnt lgkmcnt(6)
    v_mfma_f32_32x32x16_bf16 v[176:191], v[220:223], v[124:127], v[176:191]
    ds_read_b128 v[216:219], v234 offset:608
    s_waitcnt lgkmcnt(6)
    v_mfma_f32_32x32x16_bf16 v[160:175], v[192:195], v[128:131], v[160:175]
    ds_read_b128 v[220:223], v234 offset:20992
    s_waitcnt lgkmcnt(6)
    v_mfma_f32_32x32x16_bf16 v[176:191], v[196:199], v[128:131], v[176:191]
    ds_read_b128 v[192:195], v234 offset:640
    s_waitcnt lgkmcnt(6)
    v_mfma_f32_32x32x16_bf16 v[160:175], v[200:203], v[132:135], v[160:175]
    ds_read_b128 v[196:199], v234 offset:21024
    s_waitcnt lgkmcnt(6)
    v_mfma_f32_32x32x16_bf16 v[176:191], v[204:207], v[132:135], v[176:191]
    ds_read_b128 v[200:203], v234 offset:672
    s_waitcnt lgkmcnt(6)
    v_mfma_f32_32x32x16_bf16 v[160:175], v[208:211], v[136:139], v[160:175]
    ds_read_b128 v[204:207], v234 offset:21056
    s_waitcnt lgkmcnt(6)
    v_mfma_f32_32x32x16_bf16 v[176:191], v[212:215], v[136:139], v[176:191]
    ds_read_b128 v[208:211], v234 offset:704
    s_waitcnt lgkmcnt(6)
    v_mfma_f32_32x32x16_bf16 v[160:175], v[216:219], v[140:143], v[160:175]
    ds_read_b128 v[212:215], v234 offset:21088
    s_waitcnt lgkmcnt(6)
    v_mfma_f32_32x32x16_bf16 v[176:191], v[220:223], v[140:143], v[176:191]
    ds_read_b128 v[216:219], v234 offset:736
    s_waitcnt lgkmcnt(6)
    v_mfma_f32_32x32x16_bf16 v[160:175], v[192:195], v[144:147], v[160:175]
    ds_read_b128 v[220:223], v234 offset:21120
    s_waitcnt lgkmcnt(6)
    v_mfma_f32_32x32x16_bf16 v[176:191], v[196:199], v[144:147], v[176:191]
    s_waitcnt lgkmcnt(5)
    v_mfma_f32_32x32x16_bf16 v[160:175], v[200:203], v[148:151], v[160:175]
    s_waitcnt lgkmcnt(4)
    v_mfma_f32_32x32x16_bf16 v[176:191], v[204:207], v[148:151], v[176:191]
    s_waitcnt lgkmcnt(3)
    v_mfma_f32_32x32x16_bf16 v[160:175], v[208:211], v[152:155], v[160:175]
    s_waitcnt lgkmcnt(2)
    v_mfma_f32_32x32x16_bf16 v[176:191], v[212:215], v[152:155], v[176:191]
    s_waitcnt lgkmcnt(1)
    v_mfma_f32_32x32x16_bf16 v[160:175], v[216:219], v[156:159], v[160:175]
    s_waitcnt lgkmcnt(0)
    v_mfma_f32_32x32x16_bf16 v[176:191], v[220:223], v[156:159], v[176:191]
    s_mov_b64 exec, 0xffff
    s_mov_b32 s15, 200000
    s_waitcnt vmcnt(0)
    buffer_load_dwordx2 v[224:225], v235, s[40:43], s14 offen sc1
    s_mov_b64 exec, -1
    v_lshlrev_b32 v233, 16, v233
    s_nop 5
    v_mul_f32 v236, v160, v176
    v_mul_f32 v237, v161, v177
    v_fmac_f32 v236, v162, v178
    v_fmac_f32 v237, v163, v179
    v_fmac_f32 v236, v164, v180
    v_fmac_f32 v237, v165, v181
    v_fmac_f32 v236, v166, v182
    v_fmac_f32 v237, v167, v183
    v_fmac_f32 v236, v168, v184
    v_fmac_f32 v237, v169, v185
    v_fmac_f32 v236, v170, v186
    v_fmac_f32 v237, v171, v187
    v_fmac_f32 v236, v172, v188
    v_add_f32 v236, v236, v237
    v_mov_b32 v237, v236
    s_nop 1
    v_permlane32_swap_b32 v236, v237
    v_add_f32 v236, v236, v237
    v_mov_b32 v237, v236
    s_nop 1
    v_permlane16_swap_b32 v236, v237
    v_add_f32 v236, v236, v237
    s_mov_b64 exec, 1
    v_add_f32 v236, v236, v233
    s_mov_b64 exec, 0xffff
    s_branch L_pollP_chk
L_pollP:
    buffer_load_dwordx2 v[224:225], v235, s[40:43], s14 offen sc1
    s_sub_u32 s15, s15, 1
    s_cbranch_scc1 L_pollP_done
L_pollP_chk:
    s_waitcnt vmcnt(0)
    v_cmp_ne_u32 vcc, s10, v225
    s_nop 0
    s_cbranch_vccnz L_pollP
L_pollP_done:
    s_waitcnt vmcnt(0)
    v_add_f32 v236, v236, v224
    s_nop 1
    v_add_f32_dpp v236, v236, v236 row_ror:8 row_mask:0xf bank_mask:0xf
    s_nop 1
    v_add_f32_dpp v236, v236, v236 row_ror:4 row_mask:0xf bank_mask:0xf
    s_nop 1
    v_add_f32_dpp v236, v236, v236 row_ror:2 row_mask:0xf bank_mask:0xf
    s_nop 1
    v_add_f32_dpp v236, v236, v236 row_ror:1 row_mask:0xf bank_mask:0xf
    s_mov_b64 exec, 1
    v_cvt_pk_bf16_f32 v236, v236, v236
    s_lshl_b32 s13, s12, 1
    v_mov_b32 v237, s13
    global_store_short v237, v236, s[22:23]
    s_and_b32 s13, s12, 63
    s_cbranch_scc1 L_fin
    v_mov_b32 v237, 0
    v_mov_b32 v238, s10
    buffer_store_dword v238, v237, s[40:43], s11 offen sc1
    s_branch L_fin
L_prod:
    s_cmp_ge_u32 s4, 13
    s_cbranch_scc1 L_end
    s_load_dwordx2 s[36:37], s[0:1], 16
    s_load_dwordx2 s[26:27], s[0:1], 24
    s_load_dwordx2 s[24:25], s[0:1], 72
    s_setprio 3
    s_mov_b32 s38, 105456
    v_mov_b32 v131, 0x7fff0000
    s_cmp_eq_u32 s3, 0
    s_cbranch_scc1 L_powner
    s_mul_i32 s12, s3, 57
    s_sub_u32 s12, s12, 57
    v_add_u32 v127, s12, v1
    v_cmp_gt_u32 vcc, 57, v1
    v_mov_b32 v128, 169
    v_cmp_gt_u32 s[62:63], v128, v127
    s_and_b64 s[62:63], s[62:63], vcc
    v_lshlrev_b32 v128, 3, v127
    v_cndmask_b32 v128, v131, v128, s[62:63]
    s_mov_b32 s14, 70304
    s_waitcnt lgkmcnt(0)
    s_load_dwordx8 s[48:55], s[26:27], 104
    s_load_dwordx4 s[56:59], s[26:27], 136
    s_load_dword s60, s[26:27], 152
    buffer_load_dwordx2 v[32:33], v128, s[36:39], s14 offen offset:0
    buffer_load_dwordx2 v[34:35], v128, s[36:39], s14 offen offset:1352
    buffer_load_dwordx2 v[36:37], v128, s[36:39], s14 offen offset:2704
    s_add_u32 s14, s14, 4056
    buffer_load_dwordx2 v[38:39], v128, s[36:39], s14 offen offset:0
    buffer_load_dwordx2 v[40:41], v128, s[36:39], s14 offen offset:1352
    buffer_load_dwordx2 v[42:43], v128, s[36:39], s14 offen offset:2704
    s_add_u32 s14, s14, 4056
    buffer_load_dwordx2 v[44:45], v128, s[36:39], s14 offen offset:0
    buffer_load_dwordx2 v[46:47], v128, s[36:39], s14 offen offset:1352
    buffer_load_dwordx2 v[48:49], v128, s[36:39], s14 offen offset:2704
    s_add_u32 s14, s14, 4056
    buffer_load_dwordx2 v[50:51], v128, s[36:39], s14 offen offset:0
    buffer_load_dwordx2 v[52:53], v128, s[36:39], s14 offen offset:1352
    buffer_load_dwordx2 v[54:55], v128, s[36:39], s14 offen offset:2704
    s_add_u32 s14, s14, 4056
    buffer_load_dwordx2 v[56:57], v128, s[36:39], s14 offen offset:0
    buffer_load_dwordx2 v[58:59], v128, s[36:39], s14 offen offset:1352
    buffer_load_dwordx2 v[60:61], v128, s[36:39], s14 offen offset:2704
    s_add_u32 s14, s14, 4056
    buffer_load_dwordx2 v[62:63], v128, s[36:39], s14 offen offset:0
    buffer_load_dwordx2 v[64:65], v128, s[36:39], s14 offen offset:1352
    buffer_load_dwordx2 v[66:67], v128, s[36:39], s14 offen offset:2704
    s_add_u32 s14, s14, 4056
    buffer_load_dwordx2 v[68:69], v128, s[36:39], s14 offen offset:0
    buffer_load_dwordx2 v[70:71], v128, s[36:39], s14 offen offset:1352
    buffer_load_dwordx2 v[72:73], v128, s[36:39], s14 offen offset:2704
    s_add_u32 s14, s14, 4056
    buffer_load_dwordx2 v[74:75], v128, s[36:39], s14 offen offset:0
    buffer_load_dwordx2 v[76:77], v128, s[36:39], s14 offen offset:1352
    buffer_load_dwordx2 v[78:79], v128, s[36:39], s14 offen offset:2704
    s_add_u32 s14, s14, 4056
    buffer_load_dwordx2 v[80:81], v128, s[36:39], s14 offen offset:0
    buffer_load_dwordx2 v[82:83], v128, s[36:39], s14 offen offset:1352
    s_barrier
    v_lshl_add_u32 v128, v127, 2, 0
    v_mul_u32_u24 v131, 2521, v128
    v_lshrrev_b32 v131, 16, v131
    v_mul_u32_u24 v120, 26, v131
    v_sub_u32 v128, v128, v120
    v_lshlrev_b32 v128, 6, v128
    v_lshl_add_u32 v120, v131, 1, v128
    v_lshl_add_u32 v128, v127, 2, 1
    v_mul_u32_u24 v131, 2521, v128
    v_lshrrev_b32 v131, 16, v131
    v_mul_u32_u24 v121, 26, v131
    v_sub_u32 v128, v128, v121
    v_lshlrev_b32 v128, 6, v128
    v_lshl_add_u32 v121, v131, 1, v128
    v_lshl_add_u32 v128, v127, 2, 2
    v_mul_u32_u24 v131, 2521, v128
    v_lshrrev_b32 v131, 16, v131
    v_mul_u32_u24 v122, 26, v131
    v_sub_u32 v128, v128, v122
    v_lshlrev_b32 v128, 6, v128
    v_lshl_add_u32 v122, v131, 1, v128
    v_lshl_add_u32 v128, v127, 2, 3
    v_mul_u32_u24 v131, 2521, v128
    v_lshrrev_b32 v131, 16, v131
    v_mul_u32_u24 v123, 26, v131
    v_sub_u32 v128, v128, v123
    v_lshlrev_b32 v128, 6, v128
    v_lshl_add_u32 v123, v131, 1, v128
    v_mov_b32 v84, 0
    v_mov_b32 v85, 0
    v_mov_b32 v86, 0
    v_mov_b32 v87, 0
    s_mov_b32 s30, 0x05040100
    s_mov_b32 s31, 0x07060302
    s_waitcnt lgkmcnt(0)
    s_waitcnt vmcnt(24)
    v_perm_b32 v184, v34, v32, s30
    v_perm_b32 v185, v34, v32, s31
    v_perm_b32 v186, v35, v33, s30
    v_perm_b32 v187, v35, v33, s31
    v_dot2c_f32_bf16 v84, s48, v184
    v_dot2c_f32_bf16 v85, s48, v185
    v_dot2c_f32_bf16 v86, s48, v186
    v_dot2c_f32_bf16 v87, s48, v187
    s_waitcnt vmcnt(22)
    v_perm_b32 v188, v38, v36, s30
    v_perm_b32 v189, v38, v36, s31
    v_perm_b32 v190, v39, v37, s30
    v_perm_b32 v191, v39, v37, s31
    v_dot2c_f32_bf16 v84, s49, v188
    v_dot2c_f32_bf16 v85, s49, v189
    v_dot2c_f32_bf16 v86, s49, v190
    v_dot2c_f32_bf16 v87, s49, v191
    s_waitcnt vmcnt(20)
    v_perm_b32 v184, v42, v40, s30
    v_perm_b32 v185, v42, v40, s31
    v_perm_b32 v186, v43, v41, s30
    v_perm_b32 v187, v43, v41, s31
    v_dot2c_f32_bf16 v84, s50, v184
    v_dot2c_f32_bf16 v85, s50, v185
    v_dot2c_f32_bf16 v86, s50, v186
    v_dot2c_f32_bf16 v87, s50, v187
    s_waitcnt vmcnt(18)
    v_perm_b32 v188, v46, v44, s30
    v_perm_b32 v189, v46, v44, s31
    v_perm_b32 v190, v47, v45, s30
    v_perm_b32 v191, v47, v45, s31
    v_dot2c_f32_bf16 v84, s51, v188
    v_dot2c_f32_bf16 v85, s51, v189
    v_dot2c_f32_bf16 v86, s51, v190
    v_dot2c_f32_bf16 v87, s51, v191
    s_waitcnt vmcnt(16)
    v_perm_b32 v184, v50, v48, s30
    v_perm_b32 v185, v50, v48, s31
    v_perm_b32 v186, v51, v49, s30
    v_perm_b32 v187, v51, v49, s31
    v_dot2c_f32_bf16 v84, s52, v184
    v_dot2c_f32_bf16 v85, s52, v185
    v_dot2c_f32_bf16 v86, s52, v186
    v_dot2c_f32_bf16 v87, s52, v187
    s_waitcnt vmcnt(14)
    v_perm_b32 v188, v54, v52, s30
    v_perm_b32 v189, v54, v52, s31
    v_perm_b32 v190, v55, v53, s30
    v_perm_b32 v191, v55, v53, s31
    v_dot2c_f32_bf16 v84, s53, v188
    v_dot2c_f32_bf16 v85, s53, v189
    v_dot2c_f32_bf16 v86, s53, v190
    v_dot2c_f32_bf16 v87, s53, v191
    s_waitcnt vmcnt(12)
    v_perm_b32 v184, v58, v56, s30
    v_perm_b32 v185, v58, v56, s31
    v_perm_b32 v186, v59, v57, s30
    v_perm_b32 v187, v59, v57, s31
    v_dot2c_f32_bf16 v84, s54, v184
    v_dot2c_f32_bf16 v85, s54, v185
    v_dot2c_f32_bf16 v86, s54, v186
    v_dot2c_f32_bf16 v87, s54, v187
    s_waitcnt vmcnt(10)
    v_perm_b32 v188, v62, v60, s30
    v_perm_b32 v189, v62, v60, s31
    v_perm_b32 v190, v63, v61, s30
    v_perm_b32 v191, v63, v61, s31
    v_dot2c_f32_bf16 v84, s55, v188
    v_dot2c_f32_bf16 v85, s55, v189
    v_dot2c_f32_bf16 v86, s55, v190
    v_dot2c_f32_bf16 v87, s55, v191
    s_waitcnt vmcnt(8)
    v_perm_b32 v184, v66, v64, s30
    v_perm_b32 v185, v66, v64, s31
    v_perm_b32 v186, v67, v65, s30
    v_perm_b32 v187, v67, v65, s31
    v_dot2c_f32_bf16 v84, s56, v184
    v_dot2c_f32_bf16 v85, s56, v185
    v_dot2c_f32_bf16 v86, s56, v186
    v_dot2c_f32_bf16 v87, s56, v187
    s_waitcnt vmcnt(6)
    v_perm_b32 v188, v70, v68, s30
    v_perm_b32 v189, v70, v68, s31
    v_perm_b32 v190, v71, v69, s30
    v_perm_b32 v191, v71, v69, s31
    v_dot2c_f32_bf16 v84, s57, v188
    v_dot2c_f32_bf16 v85, s57, v189
    v_dot2c_f32_bf16 v86, s57, v190
    v_dot2c_f32_bf16 v87, s57, v191
    s_waitcnt vmcnt(4)
    v_perm_b32 v184, v74, v72, s30
    v_perm_b32 v185, v74, v72, s31
    v_perm_b32 v186, v75, v73, s30
    v_perm_b32 v187, v75, v73, s31
    v_dot2c_f32_bf16 v84, s58, v184
    v_dot2c_f32_bf16 v85, s58, v185
    v_dot2c_f32_bf16 v86, s58, v186
    v_dot2c_f32_bf16 v87, s58, v187
    s_waitcnt vmcnt(2)
    v_perm_b32 v188, v78, v76, s30
    v_perm_b32 v189, v78, v76, s31
    v_perm_b32 v190, v79, v77, s30
    v_perm_b32 v191, v79, v77, s31
    v_dot2c_f32_bf16 v84, s59, v188
    v_dot2c_f32_bf16 v85, s59, v189
    v_dot2c_f32_bf16 v86, s59, v190
    v_dot2c_f32_bf16 v87, s59, v191
    s_waitcnt vmcnt(0)
    v_perm_b32 v184, v82, v80, s30
    v_perm_b32 v185, v82, v80, s31
    v_perm_b32 v186, v83, v81, s30
    v_perm_b32 v187, v83, v81, s31
    v_dot2c_f32_bf16 v84, s60, v184
    v_dot2c_f32_bf16 v85, s60, v185
    v_dot2c_f32_bf16 v86, s60, v186
    v_dot2c_f32_bf16 v87, s60, v187
    s_nop 0
    v_cvt_pk_bf16_f32 v84, v84, v85
    s_nop 0
    v_cvt_pk_bf16_f32 v86, v86, v87
    s_mov_b64 exec, s[62:63]
    ds_write_b16 v120, v84
    ds_write_b16_d16_hi v121, v84
    ds_write_b16 v122, v86
    ds_write_b16_d16_hi v123, v86
    s_waitcnt lgkmcnt(0)
    s_barrier
    s_branch L_fin
L_powner:
    v_and_b32 v124, 31, v1
    v_lshrrev_b32 v125, 5, v1
    v_cmp_gt_u32 vcc, 26, v124
    v_mul_u32_u24 v127, 52, v124
    v_lshl_add_u32 v127, v125, 4, v127
    v_cndmask_b32 v127, v131, v127, vcc
    v_mul_u32_u24 v126, 10816, v125
    v_lshl_add_u32 v126, v124, 1, v126
    v_cndmask_b32 v126, v131, v126, vcc
    s_mul_i32 s14, s4, 2704
    s_mul_i32 s13, s4, 104
    s_add_u32 s13, s13, 35152
    v_lshlrev_b32 v129, 2, v1
    s_lshl_b32 s11, s4, 2
    s_waitcnt lgkmcnt(0)
    s_load_dword s15, s[26:27], s11
    buffer_load_dwordx4 v[136:139], v127, s[36:39], s14 offen offset:0
    buffer_load_dwordx4 v[140:143], v127, s[36:39], s14 offen offset:32
    buffer_load_dwordx4 v[144:147], v127, s[36:39], s14 offen offset:1352
    buffer_load_dwordx4 v[148:151], v127, s[36:39], s14 offen offset:1384
    s_mov_b64 exec, 0x1fff
    global_load_dword v130, v129, s[26:27] offset:52
    s_mov_b64 exec, -1
    v_lshlrev_b32 v217, 7, v1
    s_mov_b64 exec, 0xffff
    buffer_load_dword v217, v217, s[40:43], 0 offen sc1
    s_mov_b64 exec, -1
    buffer_load_ushort v184, v126, s[36:39], s13 offen offset:0
    buffer_load_ushort v200, v126, s[36:39], s13 offen offset:52
    buffer_load_ushort v185, v126, s[36:39], s13 offen offset:1352
    buffer_load_ushort v201, v126, s[36:39], s13 offen offset:1404
    buffer_load_ushort v186, v126, s[36:39], s13 offen offset:2704
    buffer_load_ushort v202, v126, s[36:39], s13 offen offset:2756
    s_add_u32 s13, s13, 4056
    buffer_load_ushort v187, v126, s[36:39], s13 offen offset:0
    buffer_load_ushort v203, v126, s[36:39], s13 offen offset:52
    buffer_load_ushort v188, v126, s[36:39], s13 offen offset:1352
    buffer_load_ushort v204, v126, s[36:39], s13 offen offset:1404
    buffer_load_ushort v189, v126, s[36:39], s13 offen offset:2704
    buffer_load_ushort v205, v126, s[36:39], s13 offen offset:2756
    s_add_u32 s13, s13, 4056
    buffer_load_ushort v190, v126, s[36:39], s13 offen offset:0
    buffer_load_ushort v206, v126, s[36:39], s13 offen offset:52
    buffer_load_ushort v191, v126, s[36:39], s13 offen offset:1352
    buffer_load_ushort v207, v126, s[36:39], s13 offen offset:1404
    s_add_u32 s13, s13, 13520
    buffer_load_ushort v192, v126, s[36:39], s13 offen offset:0
    buffer_load_ushort v208, v126, s[36:39], s13 offen offset:52
    buffer_load_ushort v193, v126, s[36:39], s13 offen offset:1352
    buffer_load_ushort v209, v126, s[36:39], s13 offen offset:1404
    buffer_load_ushort v194, v126, s[36:39], s13 offen offset:2704
    buffer_load_ushort v210, v126, s[36:39], s13 offen offset:2756
    s_add_u32 s13, s13, 4056
    buffer_load_ushort v195, v126, s[36:39], s13 offen offset:0
    buffer_load_ushort v211, v126, s[36:39], s13 offen offset:52
    buffer_load_ushort v196, v126, s[36:39], s13 offen offset:1352
    buffer_load_ushort v212, v126, s[36:39], s13 offen offset:1404
    buffer_load_ushort v197, v126, s[36:39], s13 offen offset:2704
    buffer_load_ushort v213, v126, s[36:39], s13 offen offset:2756
    s_add_u32 s13, s13, 4056
    buffer_load_ushort v198, v126, s[36:39], s13 offen offset:0
    buffer_load_ushort v214, v126, s[36:39], s13 offen offset:52
    buffer_load_ushort v199, v126, s[36:39], s13 offen offset:1352
    buffer_load_ushort v215, v126, s[36:39], s13 offen offset:1404
    s_barrier
    v_mov_b32 v84, 0
    v_mov_b32 v85, 0
    v_lshlrev_b32 v128, 6, v1
    v_lshlrev_b32 v126, 3, v1
    s_bfm_b64 exec, 27, 0
    ds_write_b32 v128, v84 offset:52
    ds_write_b64 v128, v[84:85] offset:56
    s_bfm_b64 exec, 40, 0
    ds_write_b64 v126, v[84:85] offset:1728
    s_mov_b64 exec, -1
    v_lshlrev_b32 v127, 3, v125
    v_sub_u32 v127, v124, v127
    v_cndmask_b32 v127, v131, v127, vcc
    v_mov_b32 v128, 0x3f80
    v_mov_b32 v126, 1.0
    v_cmp_eq_u32 vcc, 0, v127
    v_cmp_eq_u32 s[62:63], 1, v127
    s_nop 0
    v_cndmask_b32 v88, 0, v128, vcc
    v_cndmask_b32 v88, v88, v126, s[62:63]
    v_cmp_eq_u32 vcc, 2, v127
    v_cmp_eq_u32 s[62:63], 3, v127
    s_nop 0
    v_cndmask_b32 v89, 0, v128, vcc
    v_cndmask_b32 v89, v89, v126, s[62:63]
    v_cmp_eq_u32 vcc, 4, v127
    v_cmp_eq_u32 s[62:63], 5, v127
    s_nop 0
    v_cndmask_b32 v90, 0, v128, vcc
    v_cndmask_b32 v90, v90, v126, s[62:63]
    v_cmp_eq_u32 vcc, 6, v127
    v_cmp_eq_u32 s[62:63], 7, v127
    s_nop 0
    v_cndmask_b32 v91, 0, v128, vcc
    v_cndmask_b32 v91, v91, v126, s[62:63]
    v_cmp_eq_u32 vcc, 16, v127
    v_cmp_eq_u32 s[62:63], 17, v127
    s_nop 0
    v_cndmask_b32 v92, 0, v128, vcc
    v_cndmask_b32 v92, v92, v126, s[62:63]
    v_cmp_eq_u32 vcc, 18, v127
    v_cmp_eq_u32 s[62:63], 19, v127
    s_nop 0
    v_cndmask_b32 v93, 0, v128, vcc
    v_cndmask_b32 v93, v93, v126, s[62:63]
    v_cmp_eq_u32 vcc, 20, v127
    v_cmp_eq_u32 s[62:63], 21, v127
    s_nop 0
    v_cndmask_b32 v94, 0, v128, vcc
    v_cndmask_b32 v94, v94, v126, s[62:63]
    v_cmp_eq_u32 vcc, 22, v127
    v_cmp_eq_u32 s[62:63], 23, v127
    s_nop 0
    v_cndmask_b32 v95, 0, v128, vcc
    v_cndmask_b32 v95, v95, v126, s[62:63]
    v_lshlrev_b32 v127, 2, v125
    v_sub_u32 v127, v124, v127
    v_mov_b32 v128, 0.5
    v_cmp_eq_u32 vcc, 0, v127
    v_cmp_eq_u32 s[30:31], 1, v127
    s_nop 0
    v_cndmask_b32 v96, 1.0, v128, vcc
    v_cndmask_b32 v97, 1.0, v128, s[30:31]
    v_cmp_eq_u32 vcc, 2, v127
    v_cmp_eq_u32 s[30:31], 3, v127
    s_nop 0
    v_cndmask_b32 v98, 1.0, v128, vcc
    v_cndmask_b32 v99, 1.0, v128, s[30:31]
    v_cmp_eq_u32 vcc, 8, v127
    v_cmp_eq_u32 s[30:31], 9, v127
    s_nop 0
    v_cndmask_b32 v100, 1.0, v128, vcc
    v_cndmask_b32 v101, 1.0, v128, s[30:31]
    v_cmp_eq_u32 vcc, 10, v127
    v_cmp_eq_u32 s[30:31], 11, v127
    s_nop 0
    v_cndmask_b32 v102, 1.0, v128, vcc
    v_cndmask_b32 v103, 1.0, v128, s[30:31]
    v_cmp_eq_u32 vcc, 16, v127
    v_cmp_eq_u32 s[30:31], 17, v127
    s_nop 0
    v_cndmask_b32 v104, 1.0, v128, vcc
    v_cndmask_b32 v105, 1.0, v128, s[30:31]
    v_cmp_eq_u32 vcc, 18, v127
    v_cmp_eq_u32 s[30:31], 19, v127
    s_nop 0
    v_cndmask_b32 v106, 1.0, v128, vcc
    v_cndmask_b32 v107, 1.0, v128, s[30:31]
    v_cmp_eq_u32 vcc, 24, v127
    v_cmp_eq_u32 s[30:31], 25, v127
    s_nop 0
    v_cndmask_b32 v108, 1.0, v128, vcc
    v_cndmask_b32 v109, 1.0, v128, s[30:31]
    v_writelane_b32 v96, 0.5, 13
    v_writelane_b32 v101, 0.5, 32
    v_and_b32 v132, 1, v1
    v_lshrrev_b32 v133, 1, v1
    v_lshlrev_b32 v133, 3, v133
    v_add_u32 v127, 0, v133
    v_mul_u32_u24 v128, 4682, v127
    v_lshrrev_b32 v128, 16, v128
    v_mul_u32_u24 v126, 14, v128
    v_sub_u32 v126, v127, v126
    v_lshl_add_u32 v131, v128, 1, v132
    v_add_u32 v112, v131, v126
    v_subrev_u32 v128, 26, v112
    v_min_u32 v112, v112, v128
    v_cmp_lt_u32 vcc, 0xb5, v127
    v_lshlrev_b32 v131, 6, v131
    v_lshl_add_u32 v112, v112, 1, v131
    v_lshl_add_u32 v127, v127, 1, v132
    v_lshlrev_b32 v127, 1, v127
    v_add_u32 v127, 936, v127
    v_cndmask_b32 v112, v112, v127, vcc
    v_add_u32 v127, 1, v133
    v_mul_u32_u24 v128, 4682, v127
    v_lshrrev_b32 v128, 16, v128
    v_mul_u32_u24 v126, 14, v128
    v_sub_u32 v126, v127, v126
    v_lshl_add_u32 v131, v128, 1, v132
    v_add_u32 v113, v131, v126
    v_cmp_eq_u32 vcc, 13, v126
    v_cmp_le_u32 s[30:31], 7, v128
    s_and_b64 vcc, vcc, s[30:31]
    v_subrev_u32 v128, 26, v113
    v_min_u32 v113, v113, v128
    v_cndmask_b32 v113, v113, 26, vcc
    v_cmp_lt_u32 vcc, 0xb5, v127
    v_lshlrev_b32 v131, 6, v131
    v_lshl_add_u32 v113, v113, 1, v131
    v_lshl_add_u32 v127, v127, 1, v132
    v_lshlrev_b32 v127, 1, v127
    v_add_u32 v127, 936, v127
    v_cndmask_b32 v113, v113, v127, vcc
    v_add_u32 v127, 2, v133
    v_mul_u32_u24 v128, 4682, v127
    v_lshrrev_b32 v128, 16, v128
    v_mul_u32_u24 v126, 14, v128
    v_sub_u32 v126, v127, v126
    v_lshl_add_u32 v131, v128, 1, v132
    v_add_u32 v114, v131, v126
    v_subrev_u32 v128, 26, v114
    v_min_u32 v114, v114, v128
    v_cmp_lt_u32 vcc, 0xb5, v127
    v_lshlrev_b32 v131, 6, v131
    v_lshl_add_u32 v114, v114, 1, v131
    v_lshl_add_u32 v127, v127, 1, v132
    v_lshlrev_b32 v127, 1, v127
    v_add_u32 v127, 936, v127
    v_cndmask_b32 v114, v114, v127, vcc
    v_add_u32 v127, 3, v133
    v_mul_u32_u24 v128, 4682, v127
    v_lshrrev_b32 v128, 16, v128
    v_mul_u32_u24 v126, 14, v128
    v_sub_u32 v126, v127, v126
    v_lshl_add_u32 v131, v128, 1, v132
    v_add_u32 v115, v131, v126
    v_cmp_eq_u32 vcc, 13, v126
    v_cmp_le_u32 s[30:31], 7, v128
    s_and_b64 vcc, vcc, s[30:31]
    v_subrev_u32 v128, 26, v115
    v_min_u32 v115, v115, v128
    v_cndmask_b32 v115, v115, 26, vcc
    v_cmp_lt_u32 vcc, 0xb5, v127
    v_lshlrev_b32 v131, 6, v131
    v_lshl_add_u32 v115, v115, 1, v131
    v_lshl_add_u32 v127, v127, 1, v132
    v_lshlrev_b32 v127, 1, v127
    v_add_u32 v127, 936, v127
    v_cndmask_b32 v115, v115, v127, vcc
    v_add_u32 v127, 4, v133
    v_mul_u32_u24 v128, 4682, v127
    v_lshrrev_b32 v128, 16, v128
    v_mul_u32_u24 v126, 14, v128
    v_sub_u32 v126, v127, v126
    v_lshl_add_u32 v131, v128, 1, v132
    v_add_u32 v116, v131, v126
    v_subrev_u32 v128, 26, v116
    v_min_u32 v116, v116, v128
    v_cmp_lt_u32 vcc, 0xb5, v127
    v_lshlrev_b32 v131, 6, v131
    v_lshl_add_u32 v116, v116, 1, v131
    v_lshl_add_u32 v127, v127, 1, v132
    v_lshlrev_b32 v127, 1, v127
    v_add_u32 v127, 936, v127
    v_cndmask_b32 v116, v116, v127, vcc
    v_add_u32 v127, 5, v133
    v_mul_u32_u24 v128, 4682, v127
    v_lshrrev_b32 v128, 16, v128
    v_mul_u32_u24 v126, 14, v128
    v_sub_u32 v126, v127, v126
    v_lshl_add_u32 v131, v128, 1, v132
    v_add_u32 v117, v131, v126
    v_cmp_eq_u32 vcc, 13, v126
    v_cmp_le_u32 s[30:31], 7, v128
    s_and_b64 vcc, vcc, s[30:31]
    v_subrev_u32 v128, 26, v117
    v_min_u32 v117, v117, v128
    v_cndmask_b32 v117, v117, 26, vcc
    v_cmp_lt_u32 vcc, 0xb5, v127
    v_lshlrev_b32 v131, 6, v131
    v_lshl_add_u32 v117, v117, 1, v131
    v_lshl_add_u32 v127, v127, 1, v132
    v_lshlrev_b32 v127, 1, v127
    v_add_u32 v127, 936, v127
    v_cndmask_b32 v117, v117, v127, vcc
    v_add_u32 v127, 6, v133
    v_mul_u32_u24 v128, 4682, v127
    v_lshrrev_b32 v128, 16, v128
    v_mul_u32_u24 v126, 14, v128
    v_sub_u32 v126, v127, v126
    v_lshl_add_u32 v131, v128, 1, v132
    v_add_u32 v118, v131, v126
    v_subrev_u32 v128, 26, v118
    v_min_u32 v118, v118, v128
    v_cmp_lt_u32 vcc, 0xb5, v127
    v_lshlrev_b32 v131, 6, v131
    v_lshl_add_u32 v118, v118, 1, v131
    v_lshl_add_u32 v127, v127, 1, v132
    v_lshlrev_b32 v127, 1, v127
    v_add_u32 v127, 936, v127
    v_cndmask_b32 v118, v118, v127, vcc
    v_add_u32 v127, 7, v133
    v_mul_u32_u24 v128, 4682, v127
    v_lshrrev_b32 v128, 16, v128
    v_mul_u32_u24 v126, 14, v128
    v_sub_u32 v126, v127, v126
    v_lshl_add_u32 v131, v128, 1, v132
    v_add_u32 v119, v131, v126
    v_cmp_eq_u32 vcc, 13, v126
    v_cmp_le_u32 s[30:31], 7, v128
    s_and_b64 vcc, vcc, s[30:31]
    v_subrev_u32 v128, 26, v119
    v_min_u32 v119, v119, v128
    v_cndmask_b32 v119, v119, 26, vcc
    v_cmp_lt_u32 vcc, 0xb5, v127
    v_lshlrev_b32 v131, 6, v131
    v_lshl_add_u32 v119, v119, 1, v131
    v_lshl_add_u32 v127, v127, 1, v132
    v_lshlrev_b32 v127, 1, v127
    v_add_u32 v127, 936, v127
    v_cndmask_b32 v119, v119, v127, vcc
    v_lshlrev_b32 v134, 8, v125
    v_lshl_add_u32 v134, v124, 1, v134
    v_lshlrev_b32 v135, 6, v124
    v_lshl_add_u32 v135, v125, 4, v135
    s_lshl_b32 s14, s4, 1
    s_add_u32 s14, s14, 0
    s_cmp_ge_u32 s14, 13
    s_cselect_b32 s12, 13, 0
    s_cselect_b32 s11, 4, 0
    s_sub_u32 s12, s14, s12
    s_lshr_b32 s13, s12, 2
    s_lshl_b32 s13, s13, 3
    s_and_b32 s12, s12, 3
    s_add_u32 s12, s12, s13
    s_add_u32 s12, s12, s11
    s_min_u32 s28, s12, 25
    s_mul_i32 s62, s28, 768
    s_add_u32 s62, s62, 0x40000
    s_lshl_b32 s28, s28, 2
    s_lshl_b32 s14, s4, 1
    s_add_u32 s14, s14, 1
    s_cmp_ge_u32 s14, 13
    s_cselect_b32 s12, 13, 0
    s_cselect_b32 s11, 4, 0
    s_sub_u32 s12, s14, s12
    s_lshr_b32 s13, s12, 2
    s_lshl_b32 s13, s13, 3
    s_and_b32 s12, s12, 3
    s_add_u32 s12, s12, s13
    s_add_u32 s12, s12, s11
    s_min_u32 s29, s12, 25
    s_mul_i32 s63, s29, 768
    s_add_u32 s63, s63, 0x40000
    s_lshl_b32 s29, s29, 2
    v_lshlrev_b32 v124, 4, v1
    s_waitcnt vmcnt(34)
    v_mfma_f32_32x32x16_bf16 v[152:167], v[136:139], v[88:91], 0
    v_mfma_f32_32x32x16_bf16 v[168:183], v[144:147], v[88:91], 0
    v_mfma_f32_32x32x16_bf16 v[152:167], v[140:143], v[92:95], v[152:167]
    v_mfma_f32_32x32x16_bf16 v[168:183], v[148:151], v[92:95], v[168:183]
    v_mfma_f32_32x32x16_bf16 v[152:167], v[88:91], v[136:139], v[152:167]
    v_mfma_f32_32x32x16_bf16 v[168:183], v[88:91], v[144:147], v[168:183]
    v_mfma_f32_32x32x16_bf16 v[152:167], v[92:95], v[140:143], v[152:167]
    v_mfma_f32_32x32x16_bf16 v[168:183], v[92:95], v[148:151], v[168:183]
    s_nop 7
    s_nop 2
    v_mul_f32 v152, v152, v96
    v_mul_f32 v153, v153, v97
    v_mul_f32 v154, v154, v98
    v_mul_f32 v155, v155, v99
    v_mul_f32 v156, v156, v100
    v_mul_f32 v157, v157, v101
    v_mul_f32 v158, v158, v102
    v_mul_f32 v159, v159, v103
    v_mul_f32 v160, v160, v104
    v_mul_f32 v161, v161, v105
    v_mul_f32 v162, v162, v106
    v_mul_f32 v163, v163, v107
    v_mul_f32 v164, v164, v108
    v_mul_f32 v165, v165, v109
    v_writelane_b32 v166, 0, 14
    v_writelane_b32 v166, 0, 15
    v_cvt_pk_bf16_f32 v152, v152, v153
    v_cvt_pk_bf16_f32 v154, v154, v155
    v_cvt_pk_bf16_f32 v156, v156, v157
    v_cvt_pk_bf16_f32 v158, v158, v159
    v_cvt_pk_bf16_f32 v160, v160, v161
    v_cvt_pk_bf16_f32 v162, v162, v163
    v_cvt_pk_bf16_f32 v164, v164, v165
    v_cvt_pk_bf16_f32 v166, v166, v167
    ds_write_b16 v134, v152 offset:2048
    ds_write_b16_d16_hi v134, v152 offset:2112
    ds_write_b16 v134, v154 offset:2176
    ds_write_b16_d16_hi v134, v154 offset:2240
    ds_write_b16 v134, v156 offset:2560
    ds_write_b16_d16_hi v134, v156 offset:2624
    ds_write_b16 v134, v158 offset:2688
    ds_write_b16_d16_hi v134, v158 offset:2752
    ds_write_b16 v134, v160 offset:3072
    ds_write_b16_d16_hi v134, v160 offset:3136
    ds_write_b16 v134, v162 offset:3200
    ds_write_b16_d16_hi v134, v162 offset:3264
    ds_write_b16 v134, v164 offset:3584
    ds_write_b16_d16_hi v134, v164 offset:3648
    ds_write_b16 v134, v166 offset:3712
    v_mul_f32 v168, v168, v96
    v_mul_f32 v169, v169, v97
    v_mul_f32 v170, v170, v98
    v_mul_f32 v171, v171, v99
    v_mul_f32 v172, v172, v100
    v_mul_f32 v173, v173, v101
    v_mul_f32 v174, v174, v102
    v_mul_f32 v175, v175, v103
    v_mul_f32 v176, v176, v104
    v_mul_f32 v177, v177, v105
    v_mul_f32 v178, v178, v106
    v_mul_f32 v179, v179, v107
    v_mul_f32 v180, v180, v108
    v_mul_f32 v181, v181, v109
    v_writelane_b32 v182, 0, 14
    v_writelane_b32 v182, 0, 15
    v_cvt_pk_bf16_f32 v168, v168, v169
    v_cvt_pk_bf16_f32 v170, v170, v171
    v_cvt_pk_bf16_f32 v172, v172, v173
    v_cvt_pk_bf16_f32 v174, v174, v175
    v_cvt_pk_bf16_f32 v176, v176, v177
    v_cvt_pk_bf16_f32 v178, v178, v179
    v_cvt_pk_bf16_f32 v180, v180, v181
    v_cvt_pk_bf16_f32 v182, v182, v183
    ds_write_b16 v134, v168 offset:4096
    ds_write_b16_d16_hi v134, v168 offset:4160
    ds_write_b16 v134, v170 offset:4224
    ds_write_b16_d16_hi v134, v170 offset:4288
    ds_write_b16 v134, v172 offset:4608
    ds_write_b16_d16_hi v134, v172 offset:4672
    ds_write_b16 v134, v174 offset:4736
    ds_write_b16_d16_hi v134, v174 offset:4800
    ds_write_b16 v134, v176 offset:5120
    ds_write_b16_d16_hi v134, v176 offset:5184
    ds_write_b16 v134, v178 offset:5248
    ds_write_b16_d16_hi v134, v178 offset:5312
    ds_write_b16 v134, v180 offset:5632
    ds_write_b16_d16_hi v134, v180 offset:5696
    ds_write_b16 v134, v182 offset:5760
    s_bfm_b64 exec, 48, 0
    ds_read_u16 v152, v112 offset:2048
    ds_read_u16 v153, v113 offset:2048
    ds_read_u16 v154, v114 offset:2048
    ds_read_u16 v155, v115 offset:2048
    ds_read_u16 v156, v116 offset:2048
    ds_read_u16 v157, v117 offset:2048
    ds_read_u16 v158, v118 offset:2048
    ds_read_u16 v159, v119 offset:2048
    ds_read_u16 v168, v112 offset:4096
    ds_read_u16 v169, v113 offset:4096
    ds_read_u16 v170, v114 offset:4096
    ds_read_u16 v171, v115 offset:4096
    ds_read_u16 v172, v116 offset:4096
    ds_read_u16 v173, v117 offset:4096
    ds_read_u16 v174, v118 offset:4096
    ds_read_u16 v175, v119 offset:4096
    s_waitcnt vmcnt(0) lgkmcnt(8)
    v_lshl_or_b32 v160, v153, 16, v152
    v_lshl_or_b32 v161, v155, 16, v154
    v_lshl_or_b32 v162, v157, 16, v156
    v_lshl_or_b32 v163, v159, 16, v158
    buffer_store_dwordx4 v[160:163], v124, s[40:43], s62 offen offset:0 sc1
    s_waitcnt lgkmcnt(0)
    v_lshl_or_b32 v176, v169, 16, v168
    v_lshl_or_b32 v177, v171, 16, v170
    v_lshl_or_b32 v178, v173, 16, v172
    v_lshl_or_b32 v179, v175, 16, v174
    buffer_store_dwordx4 v[176:179], v124, s[40:43], s63 offen offset:0 sc1
    s_mov_b64 exec, -1
    s_add_u32 s62, s62, 19968
    s_add_u32 s63, s63, 19968
    s_mov_b64 exec, 0x1fff
    ds_write_b32 v129, v130 offset:1664
    s_mov_b64 exec, -1
    s_lshl_b32 s30, s15, 16
    s_and_b32 s31, s15, 0xffff0000
    v_lshl_or_b32 v184, v185, 16, v184
    v_lshl_or_b32 v185, v187, 16, v186
    v_lshl_or_b32 v186, v189, 16, v188
    v_lshl_or_b32 v187, v191, 16, v190
    v_lshl_or_b32 v188, v193, 16, v192
    v_lshl_or_b32 v189, v195, 16, v194
    v_lshl_or_b32 v190, v197, 16, v196
    v_lshl_or_b32 v191, v199, 16, v198
    v_lshl_or_b32 v200, v201, 16, v200
    v_lshl_or_b32 v201, v203, 16, v202
    v_lshl_or_b32 v202, v205, 16, v204
    v_lshl_or_b32 v203, v207, 16, v206
    v_lshl_or_b32 v204, v209, 16, v208
    v_lshl_or_b32 v205, v211, 16, v210
    v_lshl_or_b32 v206, v213, 16, v212
    v_lshl_or_b32 v207, v215, 16, v214
    s_waitcnt lgkmcnt(0)
    s_barrier
    ds_read_b128 v[88:91], v135
    ds_read_b128 v[92:95], v135 offset:32
    s_waitcnt lgkmcnt(0)
    v_mfma_f32_32x32x16_bf16 v[152:167], v[184:187], v[88:91], 0
    v_mfma_f32_32x32x16_bf16 v[168:183], v[200:203], v[88:91], 0
    v_mfma_f32_32x32x16_bf16 v[152:167], v[188:191], v[92:95], v[152:167]
    v_mfma_f32_32x32x16_bf16 v[168:183], v[204:207], v[92:95], v[168:183]
    v_mfma_f32_32x32x16_bf16 v[152:167], v[88:91], v[184:187], v[152:167]
    v_mfma_f32_32x32x16_bf16 v[168:183], v[88:91], v[200:203], v[168:183]
    v_mfma_f32_32x32x16_bf16 v[152:167], v[92:95], v[188:191], v[152:167]
    v_mfma_f32_32x32x16_bf16 v[168:183], v[92:95], v[204:207], v[168:183]
    s_nop 7
    s_nop 2
    v_mul_f32 v152, v152, v96
    v_mul_f32 v153, v153, v97
    v_mul_f32 v154, v154, v98
    v_mul_f32 v155, v155, v99
    v_mul_f32 v156, v156, v100
    v_mul_f32 v157, v157, v101
    v_mul_f32 v158, v158, v102
    v_mul_f32 v159, v159, v103
    v_mul_f32 v160, v160, v104
    v_mul_f32 v161, v161, v105
    v_mul_f32 v162, v162, v106
    v_mul_f32 v163, v163, v107
    v_mul_f32 v164, v164, v108
    v_mul_f32 v165, v165, v109
    v_writelane_b32 v166, s30, 14
    v_writelane_b32 v166, 0, 15
    v_cvt_pk_bf16_f32 v152, v152, v153
    v_cvt_pk_bf16_f32 v154, v154, v155
    v_cvt_pk_bf16_f32 v156, v156, v157
    v_cvt_pk_bf16_f32 v158, v158, v159
    v_cvt_pk_bf16_f32 v160, v160, v161
    v_cvt_pk_bf16_f32 v162, v162, v163
    v_cvt_pk_bf16_f32 v164, v164, v165
    v_cvt_pk_bf16_f32 v166, v166, v167
    ds_write_b16 v134, v152 offset:2048
    ds_write_b16_d16_hi v134, v152 offset:2112
    ds_write_b16 v134, v154 offset:2176
    ds_write_b16_d16_hi v134, v154 offset:2240
    ds_write_b16 v134, v156 offset:2560
    ds_write_b16_d16_hi v134, v156 offset:2624
    ds_write_b16 v134, v158 offset:2688
    ds_write_b16_d16_hi v134, v158 offset:2752
    ds_write_b16 v134, v160 offset:3072
    ds_write_b16_d16_hi v134, v160 offset:3136
    ds_write_b16 v134, v162 offset:3200
    ds_write_b16_d16_hi v134, v162 offset:3264
    ds_write_b16 v134, v164 offset:3584
    ds_write_b16_d16_hi v134, v164 offset:3648
    ds_write_b16 v134, v166 offset:3712
    v_mul_f32 v168, v168, v96
    v_mul_f32 v169, v169, v97
    v_mul_f32 v170, v170, v98
    v_mul_f32 v171, v171, v99
    v_mul_f32 v172, v172, v100
    v_mul_f32 v173, v173, v101
    v_mul_f32 v174, v174, v102
    v_mul_f32 v175, v175, v103
    v_mul_f32 v176, v176, v104
    v_mul_f32 v177, v177, v105
    v_mul_f32 v178, v178, v106
    v_mul_f32 v179, v179, v107
    v_mul_f32 v180, v180, v108
    v_mul_f32 v181, v181, v109
    v_writelane_b32 v182, s31, 14
    v_writelane_b32 v182, 0, 15
    v_cvt_pk_bf16_f32 v168, v168, v169
    v_cvt_pk_bf16_f32 v170, v170, v171
    v_cvt_pk_bf16_f32 v172, v172, v173
    v_cvt_pk_bf16_f32 v174, v174, v175
    v_cvt_pk_bf16_f32 v176, v176, v177
    v_cvt_pk_bf16_f32 v178, v178, v179
    v_cvt_pk_bf16_f32 v180, v180, v181
    v_cvt_pk_bf16_f32 v182, v182, v183
    ds_write_b16 v134, v168 offset:4096
    ds_write_b16_d16_hi v134, v168 offset:4160
    ds_write_b16 v134, v170 offset:4224
    ds_write_b16_d16_hi v134, v170 offset:4288
    ds_write_b16 v134, v172 offset:4608
    ds_write_b16_d16_hi v134, v172 offset:4672
    ds_write_b16 v134, v174 offset:4736
    ds_write_b16_d16_hi v134, v174 offset:4800
    ds_write_b16 v134, v176 offset:5120
    ds_write_b16_d16_hi v134, v176 offset:5184
    ds_write_b16 v134, v178 offset:5248
    ds_write_b16_d16_hi v134, v178 offset:5312
    ds_write_b16 v134, v180 offset:5632
    ds_write_b16_d16_hi v134, v180 offset:5696
    ds_write_b16 v134, v182 offset:5760
    s_bfm_b64 exec, 48, 0
    ds_read_u16 v152, v112 offset:2048
    ds_read_u16 v153, v113 offset:2048
    ds_read_u16 v154, v114 offset:2048
    ds_read_u16 v155, v115 offset:2048
    ds_read_u16 v156, v116 offset:2048
    ds_read_u16 v157, v117 offset:2048
    ds_read_u16 v158, v118 offset:2048
    ds_read_u16 v159, v119 offset:2048
    ds_read_u16 v168, v112 offset:4096
    ds_read_u16 v169, v113 offset:4096
    ds_read_u16 v170, v114 offset:4096
    ds_read_u16 v171, v115 offset:4096
    ds_read_u16 v172, v116 offset:4096
    ds_read_u16 v173, v117 offset:4096
    ds_read_u16 v174, v118 offset:4096
    ds_read_u16 v175, v119 offset:4096
    s_waitcnt lgkmcnt(8)
    v_lshl_or_b32 v160, v153, 16, v152
    v_lshl_or_b32 v161, v155, 16, v154
    v_lshl_or_b32 v162, v157, 16, v156
    v_lshl_or_b32 v163, v159, 16, v158
    buffer_store_dwordx4 v[160:163], v124, s[40:43], s62 offen offset:0 sc1
    s_waitcnt lgkmcnt(0)
    v_lshl_or_b32 v176, v169, 16, v168
    v_lshl_or_b32 v177, v171, 16, v170
    v_lshl_or_b32 v178, v173, 16, v172
    v_lshl_or_b32 v179, v175, 16, v174
    buffer_store_dwordx4 v[176:179], v124, s[40:43], s63 offen offset:0 sc1
    s_mov_b64 exec, -1
    s_mov_b64 exec, 0xffff
    v_add_u32 v128, 0x9e3779b9, v217
    v_lshlrev_b32 v216, 8, v1
    s_lshl_b32 s12, s4, 2
    s_add_u32 s12, s12, 0x8000
    s_waitcnt vmcnt(0)
    buffer_store_dword v128, v216, s[40:43], s12 offen sc1
L_fin:
L_end:
    s_endpgm
.section .rodata,"a"
.p2align 6
.amdhsa_kernel standalone__deep_cross_xdeepfm__recsys_kernel
  .amdhsa_next_free_vgpr 240
  .amdhsa_next_free_sgpr 102
  .amdhsa_accum_offset 240
  .amdhsa_group_segment_fixed_size 0
  .amdhsa_kernarg_size 88
  .amdhsa_user_sgpr_count 2
  .amdhsa_user_sgpr_kernarg_segment_ptr 1
  .amdhsa_system_sgpr_workgroup_id_x 1
.end_amdhsa_kernel
```
